```python
import torch

def _softmax(x, axis=-1):
    return torch.softmax(x, dim=axis)
def _gelu(x):
    return torch.nn.functional.gelu(x, approximate="tanh")
def _silu(x):
    return torch.nn.functional.silu(x)
def _sigmoid(x):
    return torch.sigmoid(x)
def _layernorm(x, axis=-1, eps=1e-5):
    m = x.mean(dim=axis, keepdim=True)
    v = x.var(dim=axis, keepdim=True, unbiased=False)
    return (x - m) / torch.sqrt(v + eps)
def _scatter_add(tgt, idx, src, axis=0):
    return tgt.clone().index_add_(axis, idx, src)
def _segment_sum(src, seg, n):
    out = torch.zeros((n,) + src.shape[1:], dtype=src.dtype)
    return out.index_add_(0, seg, src)
def _pad(x, pw):
    flat = tuple(v for pair in reversed(pw) for v in pair)
    return torch.nn.functional.pad(x, flat)

kernel_name = 'recurrent_scan__compressed_kv_cla__mixer_channel_mlp__decode'

def setup_inputs():

    _w = (lambda a: (lambda t: t.to(torch.bfloat16) if t.is_floating_point() else t)(torch.as_tensor(a)))
    def _A_setup():
        B, H, Sq, Sk, D, M = 2, 32, 1, 8192, 128, 576
        Dc = 4 * D
        return {
            "x": _w((lambda *s: torch.randn(*s, dtype=torch.bfloat16) * 0.1)(B, Sq, M)),
            "c_kv": _w((lambda *s: torch.randn(*s, dtype=torch.bfloat16) * 3.2)(B, Sk, Dc)),
            "w_q": _w((lambda *s: torch.randn(*s, dtype=torch.bfloat16) * 0.8)(M, H, D) * (M ** -0.5)),
            "w_uk": _w((lambda *s: torch.randn(*s, dtype=torch.bfloat16) * 0.8)(Dc, H, D) * (Dc ** -0.5)),
            "w_uv": _w((lambda *s: torch.randn(*s, dtype=torch.bfloat16) * 3.2)(Dc, H, D) * (Dc ** -0.5)),
            "w_o": _w((lambda *s: torch.randn(*s, dtype=torch.bfloat16) * 3.2)(H, D, M) * ((H * D) ** -0.5)),
        }
    _A_in = _A_setup()

    def _B_setup():
        B, S, D, F = 2, 1, 576, 4608
        return {
            "x": _w((lambda *s: torch.randn(*s, dtype=torch.bfloat16) * 0.1)(B, S, D)),
            "w1": _w((lambda *s: torch.randn(*s, dtype=torch.bfloat16) * 3.2)(D, F) * (D ** -0.5)),
            "b1": _w((lambda *s: torch.randn(*s, dtype=torch.bfloat16) * 3.2)(F)),
            "w2": _w((lambda *s: torch.randn(*s, dtype=torch.bfloat16) * 3.2)(F, D) * (F ** -0.5)),
            "b2": _w((lambda *s: torch.randn(*s, dtype=torch.bfloat16) * 3.2)(D)),
        }
    _B_in = _B_setup()

    return {
        "A_x": _A_in["x"],
        "A_c_kv": _A_in["c_kv"],
        "A_w_q": _A_in["w_q"],
        "A_w_uk": _A_in["w_uk"],
        "A_w_uv": _A_in["w_uv"],
        "A_w_o": _A_in["w_o"],
        "B_x": _B_in["x"],
        "B_w1": _B_in["w1"],
        "B_b1": _B_in["b1"],
        "B_w2": _B_in["w2"],
        "B_b2": _B_in["b2"],
    }

def reference(A_x, A_c_kv, A_w_q, A_w_uk, A_w_uv, A_w_o, B_x, B_w1, B_b1, B_w2, B_b2):
    def _A_ref(x, c_kv, w_q, w_uk, w_uv, w_o):
        B, Sq, M = x.shape[0], x.shape[1], x.shape[2]
        Sk = c_kv.shape[1]
        H, D = w_q.shape[1], w_q.shape[2]
        q = torch.einsum("bqm,mhd->bhqd", x, w_q)
        k = torch.einsum("bkc,chd->bhkd", c_kv, w_uk)
        v = torch.einsum("bkc,chd->bhkd", c_kv, w_uv)
        scores = torch.einsum("bhqd,bhkd->bhqk", q, k) * (D ** -0.5)
        off = Sk - Sq
        qi = torch.arange(Sq)[:, None]
        kj = torch.arange(Sk)[None, :]
        cmask = kj <= (qi + off)
        scores = torch.where(cmask[None, None], scores, -1e9)
        p = _softmax(scores, axis=-1)
        ctx = torch.einsum("bhqk,bhkd->bhqd", p, v)
        return torch.einsum("bhqd,hdm->bqm", ctx, w_o)

    def _B_ref(x, w1, b1, w2, b2):
        y = _layernorm(x, axis=-1)
        h = _gelu(torch.einsum("bsd,df->bsf", y, w1) + b1)
        return torch.einsum("bsf,fd->bsd", h, w2) + b2

    x = A_x
    xn = _layernorm(x, axis=-1)
    s = _A_ref(xn, A_c_kv, A_w_q, A_w_uk, A_w_uv, A_w_o)
    g = _silu(_B_ref(xn, B_w1, B_b1, B_w2, B_b2))
    return x + s * g
```

```asm
; @launch grid=(256,1,1) block=(768,1,1) lds=159424
.amdgcn_target "amdgcn-amd-amdhsa--gfx950"
.text
.text
.globl recurrent_scan__compressed_kv_cla__mixer_channel_mlp__decode_kernel
.p2align 8
.type recurrent_scan__compressed_kv_cla__mixer_channel_mlp__decode_kernel,@function
recurrent_scan__compressed_kv_cla__mixer_channel_mlp__decode_kernel:
    s_lshr_b32 s3, s2, 8
    s_cbranch_scc1 L_exit
    s_load_dwordx16 s[4:19], s[0:1], 0
    s_load_dwordx8 s[20:27], s[0:1], 64
    s_load_dwordx4 s[28:31], s[0:1], 96
    v_readfirstlane_b32 s3, v0
    s_and_b32 s96, s2, 7
    s_bfe_u32 s99, s2, 0x30003
    s_lshr_b32 s98, s2, 6
    s_lshl2_add_u32 s98, s96, s98
    s_lshl_b32 s41, s98, 8
    s_lshr_b32 s3, s3, 6
    s_cbranch_scc0 L_w0
    s_cmp_eq_u32 s3, 1
    s_cbranch_scc1 L_w1a
    s_getpc_b64 s[42:43]
L_pc:
    v_subrev_u32 v4, 128, v0
    v_lshlrev_b32 v5, 7, v4
    v_cmp_gt_u32 vcc, L_last-L_pc, v5
    s_nop 0
    s_and_saveexec_b64 s[44:45], vcc
    s_cbranch_execz L_nopf
    global_load_dword v167, v5, s[42:43]
    v_lshlrev_b32 v5, 2, v4
    v_add_u32 v5, 156224, v5
    v_mov_b32 v6, 0xff800000
    v_cmp_gt_u32 vcc, 16, v4
    s_nop 1
    v_cndmask_b32 v6, 0, v6, vcc
    v_cmp_gt_u32 vcc, 32, v4
    s_nop 0
    s_and_b64 exec, exec, vcc
    ds_write_b32 v5, v6
L_nopf:
    s_mov_b64 exec, -1
    v_bfe_u32 v1, v0, 4, 2
    v_and_b32 v2, 15, v0
    v_and_b32 v0, 63, v0
    s_waitcnt lgkmcnt(0)
    s_barrier
    s_branch L_disp
L_w1a:
    s_setprio 2
    v_bfe_u32 v1, v0, 4, 2
    v_and_b32 v2, 15, v0
    v_lshlrev_b32 v4, 13, v1
    v_lshl_add_u32 v4, v2, 4, v4
    s_lshl_b32 s44, s99, 19
    s_add_u32 s44, s44, s41
    s_mov_b32 s45, s44
    s_mov_b32 m0, 49920
    s_mov_b32 s34, 4194304
    s_mov_b32 s35, 0x20000
    v_and_b32 v0, 63, v0
    s_waitcnt lgkmcnt(0)
    s_mov_b32 s32, s10
    s_and_b32 s33, s11, 0xffff
    s_barrier
    buffer_load_dwordx4 v4, s[32:35], s45 offen nt lds
    s_add_u32 s45, s45, 32768
    s_add_u32 m0, m0, 1040
    s_nop 0
    buffer_load_dwordx4 v4, s[32:35], s45 offen nt lds
    s_add_u32 s45, s45, 32768
    s_add_u32 m0, m0, 1040
    s_nop 0
    buffer_load_dwordx4 v4, s[32:35], s45 offen nt lds
    s_add_u32 s45, s45, 32768
    s_add_u32 m0, m0, 1040
    s_nop 0
    buffer_load_dwordx4 v4, s[32:35], s45 offen nt lds
    s_add_u32 s45, s45, 32768
    s_add_u32 m0, m0, 1040
    s_nop 0
    buffer_load_dwordx4 v4, s[32:35], s45 offen nt lds
    s_add_u32 s45, s45, 32768
    s_add_u32 m0, m0, 1040
    s_nop 0
    buffer_load_dwordx4 v4, s[32:35], s45 offen nt lds
    s_add_u32 s45, s45, 32768
    s_add_u32 m0, m0, 1040
    s_nop 0
    buffer_load_dwordx4 v4, s[32:35], s45 offen nt lds
    s_add_u32 s45, s45, 32768
    s_add_u32 m0, m0, 1040
    s_nop 0
    buffer_load_dwordx4 v4, s[32:35], s45 offen nt lds
    s_add_u32 s45, s45, 32768
    s_add_u32 m0, m0, 1040
    s_nop 0
    buffer_load_dwordx4 v4, s[32:35], s45 offen nt lds
    s_add_u32 s45, s45, 32768
    s_add_u32 m0, m0, 1040
    s_nop 0
    buffer_load_dwordx4 v4, s[32:35], s45 offen nt lds
    s_add_u32 s45, s45, 32768
    s_add_u32 m0, m0, 1040
    s_nop 0
    buffer_load_dwordx4 v4, s[32:35], s45 offen nt lds
    s_add_u32 s45, s45, 32768
    s_add_u32 m0, m0, 1040
    s_nop 0
    buffer_load_dwordx4 v4, s[32:35], s45 offen nt lds
    s_add_u32 s45, s45, 32768
    s_add_u32 m0, m0, 1040
    s_nop 0
    buffer_load_dwordx4 v4, s[32:35], s45 offen nt lds
    s_add_u32 s45, s45, 32768
    s_add_u32 m0, m0, 1040
    s_nop 0
    buffer_load_dwordx4 v4, s[32:35], s45 offen nt lds
    s_add_u32 s45, s45, 32768
    s_add_u32 m0, m0, 1040
    s_nop 0
    buffer_load_dwordx4 v4, s[32:35], s45 offen nt lds
    s_add_u32 s45, s45, 32768
    s_add_u32 m0, m0, 1040
    s_nop 0
    buffer_load_dwordx4 v4, s[32:35], s45 offen nt lds
    s_add_u32 s45, s45, 32768
    s_add_u32 m0, m0, 1040
    s_branch L_w1
L_w0:
    s_setprio 3
    v_bfe_u32 v1, v0, 4, 2
    v_and_b32 v2, 15, v0
    v_and_b32 v26, 7, v0
    v_lshl_add_u32 v26, v1, 3, v26
    v_bfe_u32 v27, v0, 3, 1
    v_mul_u32_u24 v27, 1152, v27
    v_lshl_add_u32 v26, v26, 4, v27
    v_mad_u32_u24 v27, v1, 36, v27
    v_lshl_add_u32 v29, v1, 24, v26
    v_mul_u32_u24 v28, 147456, v1
    v_lshl_add_u32 v28, v2, 4, v28
    s_mul_i32 s43, s99, 144
    s_mul_i32 s42, s99, 589824
    s_add_u32 s42, s42, s41
    s_mov_b32 s34, 2304
    s_mov_b32 s35, 0x20000
    s_mov_b32 s38, 4718592
    s_mov_b32 s39, 0x20000
    s_waitcnt lgkmcnt(0)
    s_mov_b32 s32, s4
    s_and_b32 s33, s5, 0xffff
    s_mov_b32 s36, s8
    s_and_b32 s37, s9, 0xffff
    buffer_load_dwordx4 v[84:87], v28, s[36:39], s42 offen nt
    s_add_u32 s42, s42, 8192
    buffer_load_dwordx4 v[88:91], v28, s[36:39], s42 offen nt
    s_add_u32 s42, s42, 8192
    buffer_load_dwordx4 v[92:95], v28, s[36:39], s42 offen nt
    s_add_u32 s42, s42, 8192
    buffer_load_dwordx4 v[96:99], v28, s[36:39], s42 offen nt
    s_add_u32 s42, s42, 8192
    buffer_load_dwordx4 v[100:103], v28, s[36:39], s42 offen nt
    s_add_u32 s42, s42, 8192
    buffer_load_dwordx4 v[104:107], v28, s[36:39], s42 offen nt
    s_add_u32 s42, s42, 8192
    buffer_load_dwordx4 v[4:7], v26, s[32:35], 0 offen
    buffer_load_dwordx4 v[8:11], v26, s[32:35], 0 offen offset:512
    buffer_load_dwordx4 v[12:15], v29, s[32:35], 0 offen offset:1024
    buffer_load_dwordx4 v[16:19], v27, s[32:35], s43 offen
    buffer_load_dwordx4 v[20:23], v27, s[32:35], s43 offen offset:16
    buffer_load_dword v24, v27, s[32:35], s43 offen offset:32
    buffer_load_dwordx4 v[108:111], v28, s[36:39], s42 offen nt
    s_add_u32 s42, s42, 8192
    buffer_load_dwordx4 v[112:115], v28, s[36:39], s42 offen nt
    s_add_u32 s42, s42, 8192
    buffer_load_dwordx4 v[116:119], v28, s[36:39], s42 offen nt
    s_add_u32 s42, s42, 8192
    buffer_load_dwordx4 v[120:123], v28, s[36:39], s42 offen nt
    s_add_u32 s42, s42, 8192
    buffer_load_dwordx4 v[124:127], v28, s[36:39], s42 offen nt
    s_add_u32 s42, s42, 8192
    buffer_load_dwordx4 v[128:131], v28, s[36:39], s42 offen nt
    s_add_u32 s42, s42, 8192
    buffer_load_dwordx4 v[132:135], v28, s[36:39], s42 offen nt
    s_add_u32 s42, s42, 8192
    buffer_load_dwordx4 v[136:139], v28, s[36:39], s42 offen nt
    s_add_u32 s42, s42, 8192
    buffer_load_dwordx4 v[140:143], v28, s[36:39], s42 offen nt
    s_add_u32 s42, s42, 8192
    buffer_load_dwordx4 v[144:147], v28, s[36:39], s42 offen nt
    s_add_u32 s42, s42, 8192
    buffer_load_dwordx4 v[148:151], v28, s[36:39], s42 offen nt
    s_add_u32 s42, s42, 8192
    buffer_load_dwordx4 v[152:155], v28, s[36:39], s42 offen nt
    s_barrier
    s_and_b32 s100, s98, 1
    s_lshr_b32 s97, s2, 7
    s_lshl3_add_u32 s97, s97, s99
    s_lshr_b32 s101, s96, 2
    s_lshl4_add_u32 s101, s101, s97
    s_and_b32 s40, s96, 3
    s_lshl2_add_u32 s101, s101, s40
    v_lshlrev_b32 v3, 4, v0
    s_mov_b32 s57, 0x40000
    s_mov_b32 s62, 0x07060302
    s_mov_b32 s63, 0xfffefffe
    v_mov_b32 v36, 156288
    v_mov_b32 v38, 1
    s_load_dword s56, s[30:31], 0
    s_mov_b32 s92, s30
    s_and_b32 s93, s31, 0xffff
    s_mov_b32 s94, 268435456
    s_mov_b32 s95, 0x20000
    v_lshlrev_b32 v32, 3, v0
    v_add_u32 v33, 153856, v26
    v_and_b32 v26, 1, v0
    v_lshlrev_b32 v26, 4, v26
    v_mov_b32 v27, 0xffff
    v_lshlrev_b32 v26, v26, v27
    v_bfe_u32 v27, v0, 1, 2
    v_cmp_eq_u32 vcc, 0, v27
    s_nop 1
    v_cndmask_b32 v68, 0, v26, vcc
    v_cmp_eq_u32 vcc, 1, v27
    s_nop 1
    v_cndmask_b32 v69, 0, v26, vcc
    v_cmp_eq_u32 vcc, 2, v27
    s_nop 1
    v_cndmask_b32 v70, 0, v26, vcc
    v_cmp_eq_u32 vcc, 3, v27
    s_nop 1
    v_cndmask_b32 v71, 0, v26, vcc
    s_lshl_b32 s53, s98, 3
    s_add_u32 s53, s53, s99
    s_lshl_b32 s43, s53, 9
    s_add_u32 s54, s43, 65536
    s_xor_b32 s55, s54, 16777216
    s_mov_b32 s46, 0x3f803f80
    s_mov_b32 s47, 0x00003f80
    s_mov_b32 s48, 0x3f800000
    s_waitcnt lgkmcnt(0)
    s_add_u32 s56, s56, 2654435769
    s_bfe_u32 s58, s56, 524288
    s_bfe_u32 s59, s56, 524296
    s_bfe_u32 s60, s56, 524304
    s_bfe_u32 s61, s56, 524312
    v_and_b32 v26, 3, v0
    v_lshlrev_b32 v26, 3, v26
    v_lshrrev_b32_e64 v27, v26, s56
    v_bfe_u32 v160, v27, 0, 1
    v_bfe_u32 v26, v27, 1, 1
    v_lshl_or_b32 v160, v26, 16, v160
    v_bfe_u32 v161, v27, 2, 1
    v_bfe_u32 v26, v27, 3, 1
    v_lshl_or_b32 v161, v26, 16, v161
    v_bfe_u32 v162, v27, 4, 1
    v_bfe_u32 v26, v27, 5, 1
    v_lshl_or_b32 v162, v26, 16, v162
    v_bfe_u32 v163, v27, 6, 1
    v_bfe_u32 v26, v27, 7, 1
    v_lshl_or_b32 v163, v26, 16, v163
    v_xor_b32 v160, 0x00010001, v160
    v_xor_b32 v161, 0x00010001, v161
    v_xor_b32 v162, 0x00010001, v162
    v_xor_b32 v163, 0x00010001, v163
    v_and_b32 v26, 7, v0
    v_lshlrev_b32 v26, 2, v26
    v_lshrrev_b32_e64 v27, v26, s56
    v_bfe_u32 v164, v27, 0, 1
    v_bfe_u32 v26, v27, 1, 1
    v_lshl_or_b32 v164, v26, 16, v164
    v_bfe_u32 v165, v27, 2, 1
    v_bfe_u32 v26, v27, 3, 1
    v_lshl_or_b32 v165, v26, 16, v165
    s_waitcnt vmcnt(12)
    ds_write_b128 v33, v[4:7]
    ds_write_b128 v33, v[8:11] offset:512
    s_mov_b64 exec, 0xffff
    ds_write_b128 v33, v[12:15] offset:1024
    ds_write_b32 v36, v38 offset:20
    s_mov_b64 exec, -1
    v_dot2_f32_bf16 v26, v4, s46, 0
    v_dot2_f32_bf16 v27, v4, v4, 0
    v_dot2_f32_bf16 v26, v5, s46, v26
    v_dot2_f32_bf16 v27, v5, v5, v27
    v_dot2_f32_bf16 v26, v6, s46, v26
    v_dot2_f32_bf16 v27, v6, v6, v27
    v_dot2_f32_bf16 v26, v7, s46, v26
    v_dot2_f32_bf16 v27, v7, v7, v27
    v_dot2_f32_bf16 v26, v8, s46, v26
    v_dot2_f32_bf16 v27, v8, v8, v27
    v_dot2_f32_bf16 v26, v9, s46, v26
    v_dot2_f32_bf16 v27, v9, v9, v27
    v_dot2_f32_bf16 v26, v10, s46, v26
    v_dot2_f32_bf16 v27, v10, v10, v27
    v_dot2_f32_bf16 v26, v11, s46, v26
    v_dot2_f32_bf16 v27, v11, v11, v27
    v_dot2_f32_bf16 v26, v12, s46, v26
    v_dot2_f32_bf16 v27, v12, v12, v27
    v_dot2_f32_bf16 v26, v13, s46, v26
    v_dot2_f32_bf16 v27, v13, v13, v27
    v_dot2_f32_bf16 v26, v14, s46, v26
    v_dot2_f32_bf16 v27, v14, v14, v27
    v_dot2_f32_bf16 v26, v15, s46, v26
    v_dot2_f32_bf16 v27, v15, v15, v27
    s_nop 2
    v_add_f32_dpp v26, v26, v26 quad_perm:[1,0,3,2] row_mask:0xf bank_mask:0xf
    v_add_f32_dpp v27, v27, v27 quad_perm:[1,0,3,2] row_mask:0xf bank_mask:0xf
    s_nop 0
    v_add_f32_dpp v26, v26, v26 quad_perm:[2,3,0,1] row_mask:0xf bank_mask:0xf
    v_add_f32_dpp v27, v27, v27 quad_perm:[2,3,0,1] row_mask:0xf bank_mask:0xf
    s_nop 0
    v_add_f32_dpp v26, v26, v26 row_half_mirror row_mask:0xf bank_mask:0xf
    v_add_f32_dpp v27, v27, v27 row_half_mirror row_mask:0xf bank_mask:0xf
    v_mov_b32 v28, v26
    v_mov_b32 v29, v27
    s_nop 0
    v_permlane16_swap_b32 v26, v28
    v_permlane16_swap_b32 v27, v29
    v_add_f32 v26, v26, v28
    v_add_f32 v27, v27, v29
    v_mov_b32 v28, v26
    v_mov_b32 v29, v27
    s_nop 0
    v_permlane32_swap_b32 v26, v28
    v_permlane32_swap_b32 v27, v29
    v_add_f32 v26, v26, v28
    v_add_f32 v27, v27, v29
    v_mul_f32 v26, 0xbae38e39, v26
    v_mul_f32 v27, 0x3ae38e39, v27
    v_fma_f32 v27, -v26, v26, v27
    v_max_f32 v27, 0, v27
    v_cvt_pk_bf16_f32 v26, v26, v26
    v_and_b32 v26, 0xffff0000, v26
    v_cvt_pk_bf16_f32 v27, v27, v27
    v_and_b32 v27, 0xffff0000, v27
    v_add_f32 v27, 0x3727c5ac, v27
    v_cvt_pk_bf16_f32 v27, v27, v27
    v_and_b32 v27, 0xffff0000, v27
    v_sqrt_f32 v27, v27
    s_nop 0
    v_cvt_pk_bf16_f32 v27, v27, v27
    v_and_b32 v27, 0xffff0000, v27
    v_rcp_f32 v27, v27
    s_nop 0
    v_mul_f32 v27, 0x3e0293ee, v27
    s_nop 0
    v_readlane_b32 s49, v27, 0
    v_readlane_b32 s50, v27, 8
    v_cmp_gt_u32 vcc, 32, v0
    v_mov_b32 v27, s49
    v_mov_b32 v28, s50
    v_cndmask_b32 v27, v28, v27, vcc
    v_dot2_f32_bf16 v4, v16, s47, v26
    v_dot2_f32_bf16 v5, v16, s48, v26
    v_dot2_f32_bf16 v6, v17, s47, v26
    v_dot2_f32_bf16 v7, v17, s48, v26
    v_dot2_f32_bf16 v8, v18, s47, v26
    v_dot2_f32_bf16 v9, v18, s48, v26
    v_dot2_f32_bf16 v10, v19, s47, v26
    v_dot2_f32_bf16 v11, v19, s48, v26
    v_dot2_f32_bf16 v12, v20, s47, v26
    v_dot2_f32_bf16 v13, v20, s48, v26
    v_dot2_f32_bf16 v14, v21, s47, v26
    v_dot2_f32_bf16 v15, v21, s48, v26
    v_dot2_f32_bf16 v44, v22, s47, v26
    v_dot2_f32_bf16 v45, v22, s48, v26
    v_dot2_f32_bf16 v46, v23, s47, v26
    v_dot2_f32_bf16 v47, v23, s48, v26
    v_dot2_f32_bf16 v48, v24, s47, v26
    v_dot2_f32_bf16 v49, v24, s48, v26
    s_nop 0
    v_cvt_pk_bf16_f32 v4, v4, v4
    v_cvt_pk_bf16_f32 v5, v5, v5
    v_cvt_pk_bf16_f32 v6, v6, v6
    v_cvt_pk_bf16_f32 v7, v7, v7
    v_cvt_pk_bf16_f32 v8, v8, v8
    v_cvt_pk_bf16_f32 v9, v9, v9
    v_cvt_pk_bf16_f32 v10, v10, v10
    v_cvt_pk_bf16_f32 v11, v11, v11
    v_cvt_pk_bf16_f32 v12, v12, v12
    v_cvt_pk_bf16_f32 v13, v13, v13
    v_cvt_pk_bf16_f32 v14, v14, v14
    v_cvt_pk_bf16_f32 v15, v15, v15
    v_cvt_pk_bf16_f32 v44, v44, v44
    v_cvt_pk_bf16_f32 v45, v45, v45
    v_cvt_pk_bf16_f32 v46, v46, v46
    v_cvt_pk_bf16_f32 v47, v47, v47
    v_cvt_pk_bf16_f32 v48, v48, v48
    v_cvt_pk_bf16_f32 v49, v49, v49
    v_and_b32 v60, v4, v68
    v_and_b32 v61, v4, v69
    v_and_b32 v62, v4, v70
    v_and_b32 v63, v4, v71
    s_waitcnt vmcnt(17)
    s_nop 0
    v_mfma_f32_16x16x32_bf16 v[40:43], v[60:63], v[84:87], 0
    v_and_b32 v64, v5, v68
    v_and_b32 v65, v5, v69
    v_and_b32 v66, v5, v70
    v_and_b32 v67, v5, v71
    s_waitcnt vmcnt(16)
    s_nop 0
    v_mfma_f32_16x16x32_bf16 v[40:43], v[64:67], v[88:91], v[40:43]
    v_and_b32 v60, v6, v68
    v_and_b32 v61, v6, v69
    v_and_b32 v62, v6, v70
    v_and_b32 v63, v6, v71
    s_waitcnt vmcnt(15)
    s_nop 0
    v_mfma_f32_16x16x32_bf16 v[40:43], v[60:63], v[92:95], v[40:43]
    v_and_b32 v64, v7, v68
    v_and_b32 v65, v7, v69
    v_and_b32 v66, v7, v70
    v_and_b32 v67, v7, v71
    s_waitcnt vmcnt(14)
    s_nop 0
    v_mfma_f32_16x16x32_bf16 v[40:43], v[64:67], v[96:99], v[40:43]
    v_and_b32 v60, v8, v68
    v_and_b32 v61, v8, v69
    v_and_b32 v62, v8, v70
    v_and_b32 v63, v8, v71
    s_waitcnt vmcnt(13)
    s_nop 0
    v_mfma_f32_16x16x32_bf16 v[40:43], v[60:63], v[100:103], v[40:43]
    v_and_b32 v64, v9, v68
    v_and_b32 v65, v9, v69
    v_and_b32 v66, v9, v70
    v_and_b32 v67, v9, v71
    s_waitcnt vmcnt(12)
    v_mov_b32 v37, 2
    ds_write_b32 v36, v37 offset:16
    v_mfma_f32_16x16x32_bf16 v[40:43], v[64:67], v[104:107], v[40:43]
    v_and_b32 v60, v10, v68
    v_and_b32 v61, v10, v69
    v_and_b32 v62, v10, v70
    v_and_b32 v63, v10, v71
    s_waitcnt vmcnt(11)
    s_nop 0
    v_mfma_f32_16x16x32_bf16 v[40:43], v[60:63], v[108:111], v[40:43]
    v_and_b32 v64, v11, v68
    v_and_b32 v65, v11, v69
    v_and_b32 v66, v11, v70
    v_and_b32 v67, v11, v71
    s_waitcnt vmcnt(10)
    s_nop 0
    v_mfma_f32_16x16x32_bf16 v[40:43], v[64:67], v[112:115], v[40:43]
    v_and_b32 v60, v12, v68
    v_and_b32 v61, v12, v69
    v_and_b32 v62, v12, v70
    v_and_b32 v63, v12, v71
    s_waitcnt vmcnt(9)
    s_nop 0
    v_mfma_f32_16x16x32_bf16 v[40:43], v[60:63], v[116:119], v[40:43]
    v_and_b32 v64, v13, v68
    v_and_b32 v65, v13, v69
    v_and_b32 v66, v13, v70
    v_and_b32 v67, v13, v71
    s_waitcnt vmcnt(8)
    s_nop 0
    v_mfma_f32_16x16x32_bf16 v[40:43], v[64:67], v[120:123], v[40:43]
    v_and_b32 v60, v14, v68
    v_and_b32 v61, v14, v69
    v_and_b32 v62, v14, v70
    v_and_b32 v63, v14, v71
    s_waitcnt vmcnt(7)
    s_nop 0
    v_mfma_f32_16x16x32_bf16 v[40:43], v[60:63], v[124:127], v[40:43]
    v_and_b32 v64, v15, v68
    v_and_b32 v65, v15, v69
    v_and_b32 v66, v15, v70
    v_and_b32 v67, v15, v71
    s_waitcnt vmcnt(6)
    v_mov_b32 v37, 3
    ds_write_b32 v36, v37 offset:16
    v_mfma_f32_16x16x32_bf16 v[40:43], v[64:67], v[128:131], v[40:43]
    v_and_b32 v60, v44, v68
    v_and_b32 v61, v44, v69
    v_and_b32 v62, v44, v70
    v_and_b32 v63, v44, v71
    s_waitcnt vmcnt(5)
    s_nop 0
    v_mfma_f32_16x16x32_bf16 v[40:43], v[60:63], v[132:135], v[40:43]
    v_and_b32 v64, v45, v68
    v_and_b32 v65, v45, v69
    v_and_b32 v66, v45, v70
    v_and_b32 v67, v45, v71
    s_waitcnt vmcnt(4)
    s_nop 0
    v_mfma_f32_16x16x32_bf16 v[40:43], v[64:67], v[136:139], v[40:43]
    v_and_b32 v60, v46, v68
    v_and_b32 v61, v46, v69
    v_and_b32 v62, v46, v70
    v_and_b32 v63, v46, v71
    s_waitcnt vmcnt(3)
    s_nop 0
    v_mfma_f32_16x16x32_bf16 v[40:43], v[60:63], v[140:143], v[40:43]
    v_and_b32 v64, v47, v68
    v_and_b32 v65, v47, v69
    v_and_b32 v66, v47, v70
    v_and_b32 v67, v47, v71
    s_waitcnt vmcnt(2)
    s_nop 0
    v_mfma_f32_16x16x32_bf16 v[40:43], v[64:67], v[144:147], v[40:43]
    v_and_b32 v60, v48, v68
    v_and_b32 v61, v48, v69
    v_and_b32 v62, v48, v70
    v_and_b32 v63, v48, v71
    s_waitcnt vmcnt(1)
    s_nop 0
    v_mfma_f32_16x16x32_bf16 v[40:43], v[60:63], v[148:151], v[40:43]
    v_and_b32 v64, v49, v68
    v_and_b32 v65, v49, v69
    v_and_b32 v66, v49, v70
    v_and_b32 v67, v49, v71
    s_waitcnt vmcnt(0)
    s_nop 0
    v_mfma_f32_16x16x32_bf16 v[40:43], v[64:67], v[152:155], v[40:43]
    s_nop 7
    v_mul_f32 v40, v40, v27
    v_mul_f32 v41, v41, v27
    v_mul_f32 v42, v42, v27
    v_mul_f32 v43, v43, v27
    v_perm_b32 v34, v41, v40, s62
    v_and_or_b32 v34, v34, s63, v164
    v_perm_b32 v35, v43, v42, s62
    v_and_or_b32 v35, v35, s63, v165
    buffer_store_dwordx2 v[34:35], v32, s[92:95], s55 offen
    s_cmp_lg_u32 s97, 0
    s_cbranch_scc1 L_nci
    s_lshl_b32 s43, s100, 3
    s_add_u32 s43, s43, s96
    s_lshl_b32 s43, s43, 7
    s_add_u32 s43, s43, 327680
    v_mov_b32 v37, 0
    v_lshlrev_b32 v39, 2, v0
    s_mov_b64 exec, 0xffff
    buffer_store_dword v37, v39, s[92:95], s43 offen sc1
    s_mov_b64 exec, -1
L_nci:
    v_lshrrev_b32 v37, 3, v0
    v_xor_b32 v37, v37, v1
    v_and_b32 v37, 1, v37
    v_cmp_eq_u32 vcc, 0, v37
    v_mov_b32 v37, 0x3f803f80
    s_nop 0
    v_cndmask_b32 v37, 0, v37, vcc
    v_and_b32 v72, v37, v68
    v_and_b32 v73, v37, v69
    v_and_b32 v74, v37, v70
    v_and_b32 v75, v37, v71
    v_and_b32 v60, 7, v0
    v_lshlrev_b32 v60, 5, v60
    v_lshrrev_b32 v37, 5, v0
    v_lshl_add_u32 v60, v37, 8, v60
    v_and_b32 v39, 1, v1
    v_lshl_add_u32 v60, v39, 4, v60
    v_bfe_u32 v39, v0, 3, 1
    v_lshl_add_u32 v60, v39, 3, v60
    v_add_u32 v60, 156352, v60
    v_lshlrev_b32 v61, 8, v39
    v_lshl_add_u32 v61, v1, 4, v61
    v_add_u32 v61, 156352, v61
    v_lshlrev_b32 v63, 15, v37
    v_lshl_add_u32 v63, v2, 3, v63
    s_lshr_b32 s43, s98, 1
    s_lshl_b32 s43, s43, 10
    s_lshl_b32 s44, s100, 14
    s_add_u32 s43, s43, s44
    s_lshl_b32 s44, s99, 7
    s_add_u32 s43, s43, s44
    s_add_u32 s43, s43, 262144
    v_mul_u32_u24 v62, 1040, v2
    v_lshl_add_u32 v62, v1, 4, v62
    s_lshl_b32 s44, s98, 12
    s_add_u32 s44, s44, 16842752
    buffer_load_dwordx4 v[4:7], v3, s[92:95], s44 offen offset:0 sc1
    buffer_load_dwordx4 v[8:11], v3, s[92:95], s44 offen offset:1024 sc1
    buffer_load_dwordx4 v[12:15], v3, s[92:95], s44 offen offset:2048 sc1
    buffer_load_dwordx4 v[16:19], v3, s[92:95], s44 offen offset:3072 sc1
WF_1:
    ds_read_b32 v37, v36 offset:0
    s_sub_u32 s57, s57, 1
    s_cbranch_scc1 L_end
    s_waitcnt lgkmcnt(0)
    v_readfirstlane_b32 s40, v37
    s_nop 0
    s_cmp_lt_u32 s40, 14
    s_cbranch_scc1 WF_1
    buffer_load_dwordx4 v[40:43], v3, s[92:95], s44 offen offset:0 sc1
    buffer_load_dwordx4 v[44:47], v3, s[92:95], s44 offen offset:1024 sc1
    buffer_load_dwordx4 v[48:51], v3, s[92:95], s44 offen offset:2048 sc1
    buffer_load_dwordx4 v[52:55], v3, s[92:95], s44 offen offset:3072 sc1
WF_2:
    ds_read_b32 v37, v36 offset:0
    s_sub_u32 s57, s57, 1
    s_cbranch_scc1 L_end
    s_waitcnt lgkmcnt(0)
    v_readfirstlane_b32 s40, v37
    s_nop 0
    s_cmp_lt_u32 s40, 24
    s_cbranch_scc1 WF_2
    buffer_load_dwordx4 v[28:31], v3, s[92:95], s44 offen offset:0 sc1
    buffer_load_dwordx4 v[56:59], v3, s[92:95], s44 offen offset:1024 sc1
    buffer_load_dwordx4 v[64:67], v3, s[92:95], s44 offen offset:2048 sc1
    buffer_load_dwordx4 v[156:159], v3, s[92:95], s44 offen offset:3072 sc1
    ds_read_b128 v[84:87], v62 offset:49920
    ds_read_b128 v[88:91], v62 offset:50176
    ds_read_b128 v[92:95], v62 offset:50432
    ds_read_b128 v[96:99], v62 offset:50688
    ds_read_b128 v[100:103], v62 offset:49984
    ds_read_b128 v[104:107], v62 offset:50240
    ds_read_b128 v[108:111], v62 offset:50496
    ds_read_b128 v[112:115], v62 offset:50752
    ds_read_b128 v[116:119], v62 offset:50048
    ds_read_b128 v[120:123], v62 offset:50304
    ds_read_b128 v[124:127], v62 offset:50560
    ds_read_b128 v[128:131], v62 offset:50816
    ds_read_b128 v[132:135], v62 offset:50112
    ds_read_b128 v[136:139], v62 offset:50368
    ds_read_b128 v[140:143], v62 offset:50624
    ds_read_b128 v[144:147], v62 offset:50880
    ds_write_b32 v36, v38 offset:44
    s_mov_b32 s47, 0
    s_waitcnt vmcnt(8)
L_h1:
    v_xor_b32 v4, v160, v4
    v_xor_b32 v5, v161, v5
    v_xor_b32 v6, v162, v6
    v_xor_b32 v7, v163, v7
    v_and_b32 v20, v4, v5
    v_bitop3_b32 v20, v6, v7, v20 bitop3:0x80
    v_mfma_f32_16x16x32_bf16 v[24:27], v[72:75], v[4:7], 0
    v_xor_b32 v8, v160, v8
    v_xor_b32 v9, v161, v9
    v_xor_b32 v10, v162, v10
    v_xor_b32 v11, v163, v11
    v_bitop3_b32 v20, v8, v9, v20 bitop3:0x80
    v_bitop3_b32 v20, v10, v11, v20 bitop3:0x80
    v_mfma_f32_16x16x32_bf16 v[24:27], v[72:75], v[8:11], v[24:27]
    v_xor_b32 v12, v160, v12
    v_xor_b32 v13, v161, v13
    v_xor_b32 v14, v162, v14
    v_xor_b32 v15, v163, v15
    v_bitop3_b32 v20, v12, v13, v20 bitop3:0x80
    v_bitop3_b32 v20, v14, v15, v20 bitop3:0x80
    v_mfma_f32_16x16x32_bf16 v[24:27], v[72:75], v[12:15], v[24:27]
    v_xor_b32 v16, v160, v16
    v_xor_b32 v17, v161, v17
    v_xor_b32 v18, v162, v18
    v_xor_b32 v19, v163, v19
    v_bitop3_b32 v20, v16, v17, v20 bitop3:0x80
    v_bitop3_b32 v20, v18, v19, v20 bitop3:0x80
    v_mfma_f32_16x16x32_bf16 v[24:27], v[72:75], v[16:19], v[24:27]
    v_bitop3_b32 v20, v20, s63, s63 bitop3:0x03
    v_cmp_ne_u32 vcc, 0, v20
    s_cbranch_vccnz L_h1r
    s_nop 4
    v_cvt_pk_bf16_f32 v24, v24, v25
    v_cvt_pk_bf16_f32 v25, v26, v27
    ds_write_b64 v60, v[24:25]
    ds_read_b128 v[4:7], v61 offset:0
    ds_read_b128 v[8:11], v61 offset:64
    ds_read_b128 v[12:15], v61 offset:128
    ds_read_b128 v[16:19], v61 offset:192
    s_waitcnt lgkmcnt(3)
    v_mfma_f32_16x16x32_bf16 v[76:79], v[4:7], v[84:87], 0
    v_mfma_f32_16x16x32_bf16 v[80:83], v[4:7], v[88:91], 0
    v_mfma_f32_16x16x32_bf16 v[148:151], v[4:7], v[92:95], 0
    v_mfma_f32_16x16x32_bf16 v[152:155], v[4:7], v[96:99], 0
    s_waitcnt lgkmcnt(2)
    v_mfma_f32_16x16x32_bf16 v[76:79], v[8:11], v[100:103], v[76:79]
    v_mfma_f32_16x16x32_bf16 v[80:83], v[8:11], v[104:107], v[80:83]
    v_mfma_f32_16x16x32_bf16 v[148:151], v[8:11], v[108:111], v[148:151]
    v_mfma_f32_16x16x32_bf16 v[152:155], v[8:11], v[112:115], v[152:155]
    s_waitcnt lgkmcnt(1)
    v_mfma_f32_16x16x32_bf16 v[76:79], v[12:15], v[116:119], v[76:79]
    v_mfma_f32_16x16x32_bf16 v[80:83], v[12:15], v[120:123], v[80:83]
    v_mfma_f32_16x16x32_bf16 v[148:151], v[12:15], v[124:127], v[148:151]
    v_mfma_f32_16x16x32_bf16 v[152:155], v[12:15], v[128:131], v[152:155]
    s_waitcnt lgkmcnt(0)
    v_mfma_f32_16x16x32_bf16 v[76:79], v[16:19], v[132:135], v[76:79]
    v_mfma_f32_16x16x32_bf16 v[80:83], v[16:19], v[136:139], v[80:83]
    v_mfma_f32_16x16x32_bf16 v[148:151], v[16:19], v[140:143], v[148:151]
    v_mfma_f32_16x16x32_bf16 v[152:155], v[16:19], v[144:147], v[152:155]
    s_nop 5
    v_perm_b32 v20, v80, v76, s62
    v_and_or_b32 v20, v20, s63, v164
    v_perm_b32 v21, v152, v148, s62
    v_and_or_b32 v21, v21, s63, v165
    s_mov_b32 exec_lo, 0xffff
    s_mov_b32 exec_hi, 0xffff
    buffer_store_dwordx2 v[20:21], v63, s[92:95], s43 offen sc1
    s_mov_b64 exec, -1
    s_waitcnt vmcnt(1)
    s_mov_b32 s36, s14
    s_and_b32 s37, s15, 0xffff
    s_mov_b32 s38, 4718592
    s_mov_b32 s39, 0x20000
    v_mul_u32_u24 v18, 4608, v1
    v_lshl_add_u32 v18, v2, 4, v18
    v_mov_b32 v19, 0x7f000000
    v_cmp_gt_u32 vcc, 8, v2
    s_nop 1
    v_cndmask_b32 v19, v19, v18, vcc
    s_mov_b32 s48, 16384
    v_mov_b32 v46, 0x7f000000
    v_cmp_gt_u32 vcc, 8, v2
    v_lshrrev_b32 v47, 2, v0
    v_mul_lo_u32 v47, s48, v47
    v_and_b32 v48, 3, v0
    v_lshl_add_u32 v47, v48, 4, v47
    v_lshrrev_b32 v49, 2, v2
    v_lshl_add_u32 v49, v1, 1, v49
    v_mul_lo_u32 v49, s48, v49
    v_lshl_add_u32 v48, v48, 4, v49
    v_cndmask_b32 v48, v46, v48, vcc
    v_mov_b32 v56, s58
    v_mov_b32 v57, s59
    v_mov_b32 v58, s60
    v_mov_b32 v59, s61
    s_mov_b32 s41, 0xffffff00
    s_mov_b32 s48, 262144
    s_and_b32 s45, s96, 6
    s_bfe_u32 s42, s98, 0x10001
    s_add_u32 s45, s45, s42
    s_lshl_b32 s49, s45, 5
    s_lshl_b32 s42, s100, 4
    s_add_u32 s49, s49, s42
    s_lshl_b32 s42, s99, 1
    s_add_u32 s49, s49, s42
    s_and_b32 s43, s96, 1
    s_add_u32 s49, s49, s43
    s_lshl_b32 s49, s49, 6
    s_add_u32 s49, s49, 2097152
    s_lshl_b32 s45, s45, 2
    s_lshl_b32 s42, s100, 1
    s_add_u32 s45, s45, s42
    s_add_u32 s45, s45, s43
    s_lshl_b32 s45, s45, 7
    s_mul_i32 s42, s99, 36864
    s_add_u32 s45, s45, s42
    s_add_u32 s45, s45, 1572864
    v_lshrrev_b32 v55, 2, v0
    v_lshlrev_b32 v55, 12, v55
    v_and_b32 v51, 3, v0
    v_lshl_add_u32 v55, v51, 4, v55
    v_cmp_gt_u32 vcc, 36, v0
    s_nop 1
    v_cndmask_b32 v55, v46, v55, vcc
    v_mov_b32 v64, s56
    v_mov_b32 v65, s56
    v_mov_b32 v66, s56
    v_mov_b32 v67, s56
    s_getreg_b32 s43, hwreg(HW_REG_XCC_ID, 0, 3)
    v_xor_b32 v60, s43, v56
    v_xor_b32 v61, s43, v57
    v_xor_b32 v62, s43, v58
    v_xor_b32 v63, s43, v59
    v_and_b32 v50, 7, v0
    v_lshlrev_b32 v52, 7, v50
    v_bfe_u32 v51, v0, 3, 1
    v_lshl_add_u32 v52, v51, 6, v52
    v_lshl_add_u32 v52, v1, 4, v52
    v_lshlrev_b32 v45, 4, v50
    v_lshrrev_b32 v44, 3, v0
    v_lshl_add_u32 v45, v44, 10, v45
    v_add_u32 v44, 158400, v3
    v_lshlrev_b32 v50, 4, v50
    v_lshl_add_u32 v50, v1, 7, v50
    v_lshl_add_u32 v50, v51, 9, v50
    v_lshlrev_b32 v53, 4, v51
    v_add_u32 v53, 156160, v53
    s_lshl_b32 s50, s53, 10
    s_add_u32 s50, s50, 17301504
    s_mov_b32 s46, 0
    s_mul_i32 s42, s53, 18432
    s_lshl_b32 s51, s98, 13
    s_lshl_b32 s52, s99, 7
    s_add_u32 s51, s51, s52
    s_add_u32 s51, s51, 524288
    v_lshlrev_b32 v51, 3, v3
WF_3:
    s_sleep 2
    ds_read_b32 v37, v36 offset:0
    s_sub_u32 s57, s57, 1
    s_cbranch_scc1 L_end
    s_waitcnt lgkmcnt(0)
    v_readfirstlane_b32 s40, v37
    s_nop 0
    s_cmp_lt_u32 s40, 77
    s_cbranch_scc1 WF_3
    buffer_load_dwordx4 v[72:75], v18, s[36:39], s42 offen offset:0 nt
    buffer_load_dwordx4 v[76:79], v18, s[36:39], s42 offen offset:1152 nt
    buffer_load_dwordx4 v[80:83], v18, s[36:39], s42 offen offset:2304 nt
    buffer_load_dwordx4 v[84:87], v18, s[36:39], s42 offen offset:3456 nt
    s_add_u32 s42, s42, 256
    buffer_load_dwordx4 v[88:91], v18, s[36:39], s42 offen offset:0 nt
WF_4:
    s_sleep 2
    ds_read_b32 v37, v36 offset:0
    s_sub_u32 s57, s57, 1
    s_cbranch_scc1 L_end
    s_waitcnt lgkmcnt(0)
    v_readfirstlane_b32 s40, v37
    s_nop 0
    s_cmp_lt_u32 s40, 93
    s_cbranch_scc1 WF_4
    buffer_load_dwordx4 v[92:95], v18, s[36:39], s42 offen offset:1152 nt
    buffer_load_dwordx4 v[96:99], v18, s[36:39], s42 offen offset:2304 nt
    buffer_load_dwordx4 v[100:103], v18, s[36:39], s42 offen offset:3456 nt
    s_add_u32 s42, s42, 256
    buffer_load_dwordx4 v[104:107], v18, s[36:39], s42 offen offset:0 nt
    buffer_load_dwordx4 v[108:111], v18, s[36:39], s42 offen offset:1152 nt
WF_5:
    s_sleep 2
    ds_read_b32 v37, v36 offset:0
    s_sub_u32 s57, s57, 1
    s_cbranch_scc1 L_end
    s_waitcnt lgkmcnt(0)
    v_readfirstlane_b32 s40, v37
    s_nop 0
    s_cmp_lt_u32 s40, 109
    s_cbranch_scc1 WF_5
    buffer_load_dwordx4 v[112:115], v18, s[36:39], s42 offen offset:2304 nt
    buffer_load_dwordx4 v[116:119], v18, s[36:39], s42 offen offset:3456 nt
    s_add_u32 s42, s42, 256
    buffer_load_dwordx4 v[120:123], v18, s[36:39], s42 offen offset:0 nt
    buffer_load_dwordx4 v[124:127], v18, s[36:39], s42 offen offset:1152 nt
    buffer_load_dwordx4 v[128:131], v18, s[36:39], s42 offen offset:2304 nt
WF_6:
    s_sleep 2
    ds_read_b32 v37, v36 offset:0
    s_sub_u32 s57, s57, 1
    s_cbranch_scc1 L_end
    s_waitcnt lgkmcnt(0)
    v_readfirstlane_b32 s40, v37
    s_nop 0
    s_cmp_lt_u32 s40, 125
    s_cbranch_scc1 WF_6
    buffer_load_dwordx4 v[132:135], v18, s[36:39], s42 offen offset:3456 nt
    s_add_u32 s42, s42, 256
    buffer_load_dwordx4 v[136:139], v19, s[36:39], s42 offen offset:0 nt
    buffer_load_dwordx4 v[140:143], v19, s[36:39], s42 offen offset:1152 nt
    buffer_load_dwordx4 v[144:147], v19, s[36:39], s42 offen offset:2304 nt
    buffer_load_dwordx4 v[148:151], v19, s[36:39], s42 offen offset:3456 nt
WF_7:
    s_sleep 2
    ds_read_b32 v37, v36 offset:0
    s_sub_u32 s57, s57, 1
    s_cbranch_scc1 L_end
    s_waitcnt lgkmcnt(0)
    v_readfirstlane_b32 s40, v37
    s_nop 0
    s_cmp_lt_u32 s40, 141
    s_cbranch_scc1 WF_7
    s_mov_b64 exec, 0xff
    buffer_load_dword v4, v51, s[92:95], s50 offen sc1
    s_mov_b64 exec, -1
    s_lshr_b32 s44, s101, 4
    s_lshl3_add_u32 s47, s100, s44
    s_lshl_b32 s47, s47, 7
    s_add_u32 s47, s47, 327680
    s_add_u32 s16, s30, s47
    s_addc_u32 s17, s31, 0
    s_mov_b32 s18, 1
    s_lshl_b32 s44, s44, 14
    s_lshl_b32 s52, s100, 17
    s_add_u32 s44, s44, s52
    s_add_u32 s44, s44, 4718592
    v_lshrrev_b32 v6, 2, v0
    v_lshlrev_b32 v6, 7, v6
    v_and_b32 v7, 3, v0
    v_lshl_add_u32 v6, v7, 4, v6
    s_barrier
    s_barrier
WF_8:
    s_sleep 1
    ds_read_b32 v37, v36 offset:0
    s_sub_u32 s57, s57, 1
    s_cbranch_scc1 L_end
    s_waitcnt lgkmcnt(0)
    v_readfirstlane_b32 s40, v37
    s_nop 0
    s_cmp_lt_u32 s40, 189
    s_cbranch_scc1 WF_8
    s_atomic_add s18, s[16:17], 0 glc
    s_barrier
    s_waitcnt lgkmcnt(0)
    s_cmp_lg_u32 s18, 15
    s_barrier
    s_cbranch_scc1 L_nlast
    buffer_store_dwordx4 v[64:67], v6, s[92:95], s44 offen sc1
    s_add_u32 s44, s44, 2048
    buffer_store_dwordx4 v[64:67], v6, s[92:95], s44 offen sc1
    s_add_u32 s44, s44, 2048
L_nlast:
    s_barrier
    ds_read_b128 v[8:11], v53
    ds_read_b128 v[12:15], v53 offset:32
    s_waitcnt lgkmcnt(0)
    v_max3_f32 v16, v8, v9, v10
    v_max_f32 v16, v16, v11
    v_sub_f32 v8, v8, v16
    v_sub_f32 v9, v9, v16
    v_sub_f32 v10, v10, v16
    v_sub_f32 v11, v11, v16
    v_exp_f32 v8, v8
    v_exp_f32 v9, v9
    v_exp_f32 v10, v10
    v_exp_f32 v11, v11
    v_mul_f32 v54, v8, v12
    v_fmac_f32 v54, v9, v13
    v_fmac_f32 v54, v10, v14
    v_fmac_f32 v54, v11, v15
    v_rcp_f32 v54, v54
L_h35:
    buffer_load_dwordx4 v[4:7], v50, s[92:95], s50 offen sc1
    s_add_u32 s46, s46, 1
    s_cmp_gt_u32 s46, 96
    s_cbranch_scc1 L_h35r
L_h35w:
    s_waitcnt vmcnt(0)
    v_xor_b32 v4, v60, v4
    v_xor_b32 v5, v61, v5
    v_xor_b32 v6, v62, v6
    v_xor_b32 v7, v63, v7
    v_or3_b32 v8, v4, v5, v6
    v_or_b32 v8, v8, v7
    v_and_b32 v8, 0xff, v8
    v_cmp_ne_u32 vcc, 0, v8
    v_add_f32_dpp v4, v4, v4 quad_perm:[1,0,3,2] row_mask:0xf bank_mask:0xf
    v_add_f32_dpp v5, v5, v5 quad_perm:[1,0,3,2] row_mask:0xf bank_mask:0xf
    v_add_f32_dpp v6, v6, v6 quad_perm:[1,0,3,2] row_mask:0xf bank_mask:0xf
    v_add_f32_dpp v7, v7, v7 quad_perm:[1,0,3,2] row_mask:0xf bank_mask:0xf
    s_cbranch_vccnz L_h35
    v_add_f32_dpp v4, v4, v4 quad_perm:[2,3,0,1] row_mask:0xf bank_mask:0xf
    v_add_f32_dpp v5, v5, v5 quad_perm:[2,3,0,1] row_mask:0xf bank_mask:0xf
    v_add_f32_dpp v6, v6, v6 quad_perm:[2,3,0,1] row_mask:0xf bank_mask:0xf
    v_add_f32_dpp v7, v7, v7 quad_perm:[2,3,0,1] row_mask:0xf bank_mask:0xf
    v_add_f32_dpp v4, v4, v4 row_half_mirror row_mask:0xf bank_mask:0xf
    v_add_f32_dpp v5, v5, v5 row_half_mirror row_mask:0xf bank_mask:0xf
    v_add_f32_dpp v6, v6, v6 row_half_mirror row_mask:0xf bank_mask:0xf
    v_add_f32_dpp v7, v7, v7 row_half_mirror row_mask:0xf bank_mask:0xf
    v_mul_f32 v4, v4, v54
    v_mul_f32 v5, v5, v54
    v_mul_f32 v6, v6, v54
    v_mul_f32 v7, v7, v54
    v_cvt_pk_bf16_f32 v4, v4, v4
    v_cvt_pk_bf16_f32 v5, v5, v5
    v_cvt_pk_bf16_f32 v6, v6, v6
    v_cvt_pk_bf16_f32 v7, v7, v7
    v_and_b32 v8, v4, v68
    v_and_b32 v9, v4, v69
    v_and_b32 v10, v4, v70
    v_and_b32 v11, v4, v71
    v_and_b32 v12, v5, v68
    v_and_b32 v13, v5, v69
    v_and_b32 v14, v5, v70
    v_and_b32 v15, v5, v71
    v_mfma_f32_16x16x32_bf16 v[24:27], v[8:11], v[72:75], 0
    v_and_b32 v16, v6, v68
    v_and_b32 v17, v6, v69
    v_and_b32 v18, v6, v70
    v_and_b32 v19, v6, v71
    v_mfma_f32_16x16x32_bf16 v[24:27], v[12:15], v[76:79], v[24:27]
    v_and_b32 v20, v7, v68
    v_and_b32 v21, v7, v69
    v_and_b32 v22, v7, v70
    v_and_b32 v23, v7, v71
    v_mfma_f32_16x16x32_bf16 v[24:27], v[16:19], v[80:83], v[24:27]
    ds_write_b32 v36, v38 offset:12
    v_mfma_f32_16x16x32_bf16 v[24:27], v[20:23], v[84:87], v[24:27]
    v_mfma_f32_16x16x32_bf16 v[28:31], v[8:11], v[88:91], 0
    v_mfma_f32_16x16x32_bf16 v[28:31], v[12:15], v[92:95], v[28:31]
    v_mfma_f32_16x16x32_bf16 v[28:31], v[16:19], v[96:99], v[28:31]
    v_mfma_f32_16x16x32_bf16 v[28:31], v[20:23], v[100:103], v[28:31]
    v_mfma_f32_16x16x32_bf16 v[32:35], v[8:11], v[104:107], 0
    v_mfma_f32_16x16x32_bf16 v[32:35], v[12:15], v[108:111], v[32:35]
    v_mfma_f32_16x16x32_bf16 v[32:35], v[16:19], v[112:115], v[32:35]
    v_mfma_f32_16x16x32_bf16 v[32:35], v[20:23], v[116:119], v[32:35]
    v_and_or_b32 v24, v24, s41, v56
    v_and_or_b32 v25, v25, s41, v57
    v_and_or_b32 v26, v26, s41, v58
    v_and_or_b32 v27, v27, s41, v59
    buffer_store_dwordx4 v[24:27], v47, s[92:95], s49 offen sc1
    s_add_u32 s49, s49, s48
    v_mfma_f32_16x16x32_bf16 v[36:39], v[8:11], v[120:123], 0
    v_mfma_f32_16x16x32_bf16 v[36:39], v[12:15], v[124:127], v[36:39]
    v_mfma_f32_16x16x32_bf16 v[36:39], v[16:19], v[128:131], v[36:39]
    v_mfma_f32_16x16x32_bf16 v[36:39], v[20:23], v[132:135], v[36:39]
    v_and_or_b32 v28, v28, s41, v56
    v_and_or_b32 v29, v29, s41, v57
    v_and_or_b32 v30, v30, s41, v58
    v_and_or_b32 v31, v31, s41, v59
    buffer_store_dwordx4 v[28:31], v47, s[92:95], s49 offen sc1
    s_add_u32 s49, s49, s48
    v_mfma_f32_16x16x32_bf16 v[40:43], v[8:11], v[136:139], 0
    v_mfma_f32_16x16x32_bf16 v[40:43], v[12:15], v[140:143], v[40:43]
    v_mfma_f32_16x16x32_bf16 v[40:43], v[16:19], v[144:147], v[40:43]
    v_mfma_f32_16x16x32_bf16 v[40:43], v[20:23], v[148:151], v[40:43]
    v_and_or_b32 v32, v32, s41, v56
    v_and_or_b32 v33, v33, s41, v57
    v_and_or_b32 v34, v34, s41, v58
    v_and_or_b32 v35, v35, s41, v59
    buffer_store_dwordx4 v[32:35], v47, s[92:95], s49 offen sc1
    s_add_u32 s49, s49, s48
    v_and_or_b32 v36, v36, s41, v56
    v_and_or_b32 v37, v37, s41, v57
    v_and_or_b32 v38, v38, s41, v58
    v_and_or_b32 v39, v39, s41, v59
    buffer_store_dwordx4 v[36:39], v47, s[92:95], s49 offen sc1
    s_add_u32 s49, s49, s48
    v_and_or_b32 v40, v40, s41, v56
    v_and_or_b32 v41, v41, s41, v57
    v_and_or_b32 v42, v42, s41, v58
    v_and_or_b32 v43, v43, s41, v59
    buffer_store_dwordx4 v[40:43], v48, s[92:95], s49 offen sc1
    buffer_store_dwordx4 v[64:67], v55, s[92:95], s45 offen sc1
    s_branch L_end
L_h1r:
    s_sub_u32 s57, s57, 1
    s_cbranch_scc1 L_end
    s_cmp_lg_u32 s47, 0
    s_cbranch_scc1 L_h1s1
    s_mov_b32 s47, 1
    s_waitcnt vmcnt(4)
    v_mov_b32 v4, v40
    v_mov_b32 v5, v41
    v_mov_b32 v6, v42
    v_mov_b32 v7, v43
    v_mov_b32 v8, v44
    v_mov_b32 v9, v45
    v_mov_b32 v10, v46
    v_mov_b32 v11, v47
    v_mov_b32 v12, v48
    v_mov_b32 v13, v49
    v_mov_b32 v14, v50
    v_mov_b32 v15, v51
    v_mov_b32 v16, v52
    v_mov_b32 v17, v53
    v_mov_b32 v18, v54
    v_mov_b32 v19, v55
    s_branch L_h1
L_h1s1:
    s_cmp_lg_u32 s47, 1
    s_cbranch_scc1 L_h1s2
    s_mov_b32 s47, 2
    s_waitcnt vmcnt(0)
    v_mov_b32 v4, v28
    v_mov_b32 v5, v29
    v_mov_b32 v6, v30
    v_mov_b32 v7, v31
    v_mov_b32 v8, v56
    v_mov_b32 v9, v57
    v_mov_b32 v10, v58
    v_mov_b32 v11, v59
    v_mov_b32 v12, v64
    v_mov_b32 v13, v65
    v_mov_b32 v14, v66
    v_mov_b32 v15, v67
    v_mov_b32 v16, v156
    v_mov_b32 v17, v157
    v_mov_b32 v18, v158
    v_mov_b32 v19, v159
    s_branch L_h1
L_h1s2:
    s_add_u32 s47, s47, 1
    s_cmp_lt_u32 s47, 24
    s_cbranch_scc1 L_h1g
    s_xor_b32 s44, s44, 16777216
    buffer_store_dwordx2 v[34:35], v32, s[92:95], s54 offen sc1
L_h1g:
    buffer_load_dwordx4 v[4:7], v3, s[92:95], s44 offen offset:0 sc1
    buffer_load_dwordx4 v[8:11], v3, s[92:95], s44 offen offset:1024 sc1
    buffer_load_dwordx4 v[12:15], v3, s[92:95], s44 offen offset:2048 sc1
    buffer_load_dwordx4 v[16:19], v3, s[92:95], s44 offen offset:3072 sc1
    s_waitcnt vmcnt(0)
    s_branch L_h1
L_h35r:
    s_sub_u32 s57, s57, 1
    s_cbranch_scc1 L_end
    s_xor_b32 s50, s50, 16777216
    v_swap_b32 v50, v52
    v_xor_b32 v60, s43, v60
    v_xor_b32 v61, s43, v61
    v_xor_b32 v62, s43, v62
    v_xor_b32 v63, s43, v63
WF_9:
    ds_read_b32 v37, v36 offset:40
    s_sub_u32 s57, s57, 1
    s_cbranch_scc1 L_end
    s_waitcnt lgkmcnt(0)
    v_readfirstlane_b32 s40, v37
    s_nop 0
    s_cmp_lt_u32 s40, 8
    s_cbranch_scc1 WF_9
    ds_read_b128 v[8:11], v44
    s_waitcnt lgkmcnt(0)
    v_xor_b32 v8, s43, v8
    v_xor_b32 v9, s43, v9
    v_xor_b32 v10, s43, v10
    v_xor_b32 v11, s43, v11
    buffer_store_dwordx4 v[8:11], v45, s[92:95], s51 offen sc1
    buffer_load_dwordx4 v[4:7], v50, s[92:95], s50 offen sc1
    s_branch L_h35w
L_disp:
    s_and_b32 s100, s98, 1
    s_lshr_b32 s97, s2, 7
    s_lshl3_add_u32 s97, s97, s99
    s_lshr_b32 s101, s96, 2
    s_lshl4_add_u32 s101, s101, s97
    s_and_b32 s40, s96, 3
    s_lshl2_add_u32 s101, s101, s40
    v_lshlrev_b32 v3, 4, v0
    s_mov_b32 s57, 0x40000
    s_mov_b32 s62, 0x07060302
    s_mov_b32 s63, 0xfffefffe
    v_mov_b32 v36, 156288
    v_mov_b32 v38, 1
    s_load_dword s56, s[30:31], 0
    s_mov_b32 s92, s30
    s_and_b32 s93, s31, 0xffff
    s_mov_b32 s94, 268435456
    s_mov_b32 s95, 0x20000
    s_mov_b32 s32, s4
    s_and_b32 s33, s5, 0xffff
    s_mov_b32 s34, 2304
    s_mov_b32 s35, 0x20000
    s_cmp_ge_u32 s3, 4
    s_cbranch_scc1 L_wa
    s_cmp_eq_u32 s3, 2
    s_cbranch_scc1 L_w2
    s_branch L_w3
L_w1:
    s_and_b32 s100, s98, 1
    s_lshr_b32 s97, s2, 7
    s_lshl3_add_u32 s97, s97, s99
    s_lshr_b32 s101, s96, 2
    s_lshl4_add_u32 s101, s101, s97
    s_and_b32 s40, s96, 3
    s_lshl2_add_u32 s101, s101, s40
    v_lshlrev_b32 v3, 4, v0
    s_mov_b32 s57, 0x40000
    s_mov_b32 s62, 0x07060302
    s_mov_b32 s63, 0xfffefffe
    v_mov_b32 v36, 156288
    v_mov_b32 v38, 1
    s_load_dword s56, s[30:31], 0
    s_mov_b32 s92, s30
    s_and_b32 s93, s31, 0xffff
    s_mov_b32 s94, 268435456
    s_mov_b32 s95, 0x20000
    s_mov_b32 s36, s6
    s_and_b32 s37, s7, 0xffff
    s_mov_b32 s38, 16777216
    s_mov_b32 s39, 0x20000
    s_mov_b32 s48, s18
    s_and_b32 s49, s19, 0xffff
    s_mov_b32 s50, 5308416
    s_mov_b32 s51, 0x20000
    s_mov_b32 s52, s22
    s_and_b32 s53, s23, 0xffff
    s_mov_b32 s54, 5308416
    s_mov_b32 s55, 0x20000
    s_mul_i32 s46, s99, 663552
    s_mul_i32 s47, s98, 288
    s_add_u32 s46, s46, s47
    s_lshl_b32 s43, s98, 3
    s_add_u32 s43, s43, s99
    s_mul_i32 s43, s43, 20736
    s_lshl_b32 s42, s96, 21
    s_lshl_b32 s47, s97, 14
    s_add_u32 s42, s42, s47
    v_mul_u32_u24 v7, 57, v0
    v_lshrrev_b32 v7, 10, v7
    v_mul_u32_u24 v7, 8928, v7
    v_add_u32 v7, v7, v3
    v_mov_b32 v9, 0x7f000000
    v_cmp_gt_u32 vcc, 54, v0
    s_nop 1
    v_cndmask_b32 v7, v9, v7, vcc
    v_cmp_gt_u32 vcc, 16, v0
    s_nop 1
    v_cndmask_b32 v8, v9, v3, vcc
WF_10:
    ds_read_b32 v37, v36 offset:16
    s_sub_u32 s57, s57, 1
    s_cbranch_scc1 L_end
    s_waitcnt lgkmcnt(0)
    v_readfirstlane_b32 s40, v37
    s_nop 0
    s_cmp_lt_u32 s40, 3
    s_cbranch_scc1 WF_10
    s_mov_b32 s32, s12
    s_and_b32 s33, s13, 0xffff
    s_mov_b32 s34, 4194304
    s_mov_b32 s35, 0x20000
    s_mov_b32 m0, 66560
    s_nop 0
    buffer_load_dwordx4 v7, s[48:51], s46 offen  lds
    s_add_u32 s46, s46, 27648
    s_mov_b32 m0, 0
    s_nop 0
    buffer_load_dwordx4 v3, s[36:39], s42 offen lds
    s_add_u32 s42, s42, 1024
    s_mov_b32 m0, 67584
    s_nop 0
    buffer_load_dwordx4 v7, s[48:51], s46 offen  lds
    s_add_u32 s46, s46, 27648
    s_mov_b32 m0, 1040
    s_nop 0
    buffer_load_dwordx4 v3, s[36:39], s42 offen lds
    s_add_u32 s42, s42, 1024
    s_mov_b32 m0, 68608
    s_nop 0
    buffer_load_dwordx4 v7, s[48:51], s46 offen  lds
    s_add_u32 s46, s46, 27648
    s_mov_b32 m0, 2080
    s_nop 0
    buffer_load_dwordx4 v3, s[36:39], s42 offen lds
    s_add_u32 s42, s42, 1024
    s_mov_b32 m0, 69632
    s_nop 0
    buffer_load_dwordx4 v7, s[48:51], s46 offen  lds
    s_add_u32 s46, s46, 27648
    s_mov_b32 m0, 3120
    s_nop 0
    buffer_load_dwordx4 v3, s[36:39], s42 offen lds
    s_add_u32 s42, s42, 1024
    s_mov_b32 m0, 70656
    s_nop 0
    buffer_load_dwordx4 v7, s[48:51], s46 offen  lds
    s_add_u32 s46, s46, 27648
    s_mov_b32 m0, 4160
    s_nop 0
    buffer_load_dwordx4 v3, s[36:39], s42 offen lds
    s_add_u32 s42, s42, 1024
    s_mov_b32 m0, 71680
    s_waitcnt vmcnt(25)
    buffer_load_dwordx4 v7, s[48:51], s46 offen  lds
    s_add_u32 s46, s46, 27648
    s_mov_b32 m0, 5200
    s_waitcnt vmcnt(26)
    buffer_load_dwordx4 v3, s[36:39], s42 offen lds
    s_add_u32 s42, s42, 1024
    s_mov_b32 m0, 72704
    s_waitcnt vmcnt(26)
    buffer_load_dwordx4 v7, s[48:51], s46 offen  lds
    s_add_u32 s46, s46, 27648
    s_mov_b32 m0, 6240
    s_waitcnt vmcnt(26)
    buffer_load_dwordx4 v3, s[36:39], s42 offen lds
    s_add_u32 s42, s42, 1024
    s_mov_b32 m0, 73728
    s_waitcnt vmcnt(26)
    buffer_load_dwordx4 v7, s[48:51], s46 offen  lds
    s_add_u32 s46, s46, 27648
    s_mov_b32 m0, 7280
    s_waitcnt vmcnt(27)
    buffer_load_dwordx4 v3, s[36:39], s42 offen lds
    s_add_u32 s42, s42, 1024
    s_mov_b32 m0, 74752
    s_waitcnt vmcnt(27)
    buffer_load_dwordx4 v7, s[48:51], s46 offen  lds
    s_add_u32 s46, s46, 27648
    s_mov_b32 m0, 8320
    s_waitcnt vmcnt(27)
    buffer_load_dwordx4 v3, s[36:39], s42 offen lds
    s_add_u32 s42, s42, 1024
    s_mov_b32 m0, 75776
    s_waitcnt vmcnt(27)
    buffer_load_dwordx4 v7, s[48:51], s46 offen  lds
    s_add_u32 s46, s46, 27648
    s_mov_b32 m0, 9360
    s_waitcnt vmcnt(28)
    buffer_load_dwordx4 v3, s[36:39], s42 offen lds
    s_add_u32 s42, s42, 1024
    s_mov_b32 m0, 76800
    s_waitcnt vmcnt(28)
    buffer_load_dwordx4 v7, s[48:51], s46 offen  lds
    s_add_u32 s46, s46, 27648
    s_mov_b32 m0, 10400
    s_waitcnt vmcnt(28)
    buffer_load_dwordx4 v3, s[36:39], s42 offen lds
    s_add_u32 s42, s42, 1024
    s_mov_b32 m0, 77824
    s_waitcnt vmcnt(28)
    buffer_load_dwordx4 v7, s[48:51], s46 offen  lds
    s_add_u32 s46, s46, 27648
    s_mov_b32 m0, 11440
    s_waitcnt vmcnt(29)
    buffer_load_dwordx4 v3, s[36:39], s42 offen lds
    s_add_u32 s42, s42, 1024
    s_mov_b32 m0, 78848
    s_waitcnt vmcnt(29)
    buffer_load_dwordx4 v7, s[48:51], s46 offen  lds
    s_add_u32 s46, s46, 27648
    s_mov_b32 m0, 12480
    s_waitcnt vmcnt(29)
    buffer_load_dwordx4 v3, s[36:39], s42 offen lds
    s_add_u32 s42, s42, 1024
    s_mov_b32 m0, 79872
    s_waitcnt vmcnt(29)
    buffer_load_dwordx4 v7, s[48:51], s46 offen  lds
    s_add_u32 s46, s46, 27648
    s_mov_b32 m0, 13520
    s_waitcnt vmcnt(30)
    buffer_load_dwordx4 v3, s[36:39], s42 offen lds
    s_add_u32 s42, s42, 1024
    s_mov_b32 m0, 80896
    s_waitcnt vmcnt(30)
    v_mov_b32 v6, 14
    ds_write_b32 v36, v6 offset:0
    buffer_load_dwordx4 v7, s[48:51], s46 offen  lds
    s_add_u32 s46, s46, 27648
    s_mov_b32 m0, 14560
    s_waitcnt vmcnt(30)
    buffer_load_dwordx4 v3, s[36:39], s42 offen lds
    s_add_u32 s42, s42, 1024
    s_mov_b32 m0, 81920
    s_waitcnt vmcnt(30)
    v_mov_b32 v6, 16
    ds_write_b32 v36, v6 offset:0
    buffer_load_dwordx4 v7, s[48:51], s46 offen  lds
    s_add_u32 s46, s46, 27648
    s_mov_b32 m0, 15600
    s_waitcnt vmcnt(31)
    buffer_load_dwordx4 v3, s[36:39], s42 offen lds
    s_add_u32 s42, s42, 246784
    s_mov_b32 m0, 82944
    s_waitcnt vmcnt(31)
    buffer_load_dwordx4 v7, s[48:51], s46 offen  lds
    s_add_u32 s46, s46, 27648
    s_mov_b32 m0, 16640
    s_waitcnt vmcnt(31)
    buffer_load_dwordx4 v3, s[36:39], s42 offen lds
    s_add_u32 s42, s42, 1024
    s_mov_b32 m0, 83968
    s_waitcnt vmcnt(31)
    buffer_load_dwordx4 v7, s[48:51], s46 offen  lds
    s_add_u32 s46, s46, 27648
    s_mov_b32 m0, 17680
    s_waitcnt vmcnt(32)
    buffer_load_dwordx4 v3, s[36:39], s42 offen lds
    s_add_u32 s42, s42, 1024
    s_mov_b32 m0, 84992
    s_waitcnt vmcnt(32)
    buffer_load_dwordx4 v7, s[48:51], s46 offen  lds
    s_add_u32 s46, s46, 27648
    s_mov_b32 m0, 18720
    s_waitcnt vmcnt(32)
    buffer_load_dwordx4 v3, s[36:39], s42 offen lds
    s_add_u32 s42, s42, 1024
    s_mov_b32 m0, 86016
    s_waitcnt vmcnt(32)
    buffer_load_dwordx4 v7, s[48:51], s46 offen  lds
    s_add_u32 s46, s46, 27648
    s_mov_b32 m0, 19760
    s_waitcnt vmcnt(32)
    buffer_load_dwordx4 v3, s[36:39], s42 offen lds
    s_add_u32 s42, s42, 1024
    s_mov_b32 m0, 87040
    s_waitcnt vmcnt(32)
    v_mov_b32 v6, 24
    ds_write_b32 v36, v6 offset:0
    buffer_load_dwordx4 v7, s[48:51], s46 offen  lds
    s_add_u32 s46, s46, 27648
    s_mov_b32 m0, 20800
    s_waitcnt vmcnt(32)
    buffer_load_dwordx4 v3, s[36:39], s42 offen lds
    s_add_u32 s42, s42, 1024
    s_mov_b32 m0, 88064
    s_waitcnt vmcnt(32)
    buffer_load_dwordx4 v7, s[48:51], s46 offen  lds
    s_add_u32 s46, s46, 27648
    s_mov_b32 m0, 21840
    s_waitcnt vmcnt(32)
    buffer_load_dwordx4 v3, s[36:39], s42 offen lds
    s_add_u32 s42, s42, 1024
    s_mov_b32 m0, 89088
    s_waitcnt vmcnt(32)
    buffer_load_dwordx4 v7, s[48:51], s46 offen  lds
    s_add_u32 s46, s46, 27648
    s_mov_b32 m0, 22880
    s_waitcnt vmcnt(32)
    buffer_load_dwordx4 v3, s[36:39], s42 offen lds
    s_add_u32 s42, s42, 1024
    s_mov_b32 m0, 90112
    s_waitcnt vmcnt(32)
    buffer_load_dwordx4 v7, s[48:51], s46 offen  lds
    s_add_u32 s46, s46, 27648
    s_mov_b32 m0, 23920
    s_waitcnt vmcnt(32)
    buffer_load_dwordx4 v3, s[36:39], s42 offen lds
    s_add_u32 s42, s42, 1024
    s_mov_b32 m0, 99840
    s_waitcnt vmcnt(32)
    buffer_load_dwordx4 v3, s[52:55], s43 offen nt lds
    s_add_u32 s43, s43, 1024
    s_mov_b32 m0, 24960
    s_waitcnt vmcnt(32)
    buffer_load_dwordx4 v3, s[36:39], s42 offen lds
    s_add_u32 s42, s42, 1024
    s_mov_b32 m0, 100864
    s_waitcnt vmcnt(32)
    buffer_load_dwordx4 v3, s[52:55], s43 offen nt lds
    s_add_u32 s43, s43, 1024
    s_mov_b32 m0, 26000
    s_waitcnt vmcnt(32)
    buffer_load_dwordx4 v3, s[36:39], s42 offen lds
    s_add_u32 s42, s42, 1024
    s_mov_b32 m0, 101888
    s_waitcnt vmcnt(32)
    buffer_load_dwordx4 v3, s[52:55], s43 offen nt lds
    s_add_u32 s43, s43, 1024
    s_mov_b32 m0, 27040
    s_waitcnt vmcnt(32)
    buffer_load_dwordx4 v3, s[36:39], s42 offen lds
    s_add_u32 s42, s42, 1024
    s_mov_b32 m0, 102912
    s_waitcnt vmcnt(32)
    buffer_load_dwordx4 v3, s[52:55], s43 offen nt lds
    s_add_u32 s43, s43, 1024
    s_mov_b32 m0, 28080
    s_waitcnt vmcnt(32)
    buffer_load_dwordx4 v3, s[36:39], s42 offen lds
    s_add_u32 s42, s42, 1024
    s_mov_b32 m0, 103936
    s_waitcnt vmcnt(32)
    buffer_load_dwordx4 v3, s[52:55], s43 offen nt lds
    s_add_u32 s43, s43, 1024
    s_mov_b32 m0, 29120
    s_waitcnt vmcnt(32)
    buffer_load_dwordx4 v3, s[36:39], s42 offen lds
    s_add_u32 s42, s42, 1024
    s_mov_b32 m0, 104960
    s_waitcnt vmcnt(32)
    buffer_load_dwordx4 v3, s[52:55], s43 offen nt lds
    s_add_u32 s43, s43, 1024
    s_mov_b32 m0, 30160
    s_waitcnt vmcnt(32)
    buffer_load_dwordx4 v3, s[36:39], s42 offen lds
    s_add_u32 s42, s42, 1024
    s_mov_b32 m0, 105984
    s_waitcnt vmcnt(32)
    buffer_load_dwordx4 v3, s[52:55], s43 offen nt lds
    s_add_u32 s43, s43, 1024
    s_mov_b32 m0, 31200
    s_waitcnt vmcnt(32)
    buffer_load_dwordx4 v3, s[36:39], s42 offen lds
    s_add_u32 s42, s42, 1024
    s_mov_b32 m0, 107008
    s_waitcnt vmcnt(32)
    buffer_load_dwordx4 v3, s[52:55], s43 offen nt lds
    s_add_u32 s43, s43, 1024
    s_mov_b32 m0, 32240
    s_waitcnt vmcnt(32)
    buffer_load_dwordx4 v3, s[36:39], s42 offen lds
    s_add_u32 s42, s42, 246784
    s_mov_b32 m0, 108032
    s_waitcnt vmcnt(32)
    buffer_load_dwordx4 v3, s[52:55], s43 offen nt lds
    s_add_u32 s43, s43, 1024
    s_mov_b32 m0, 33280
    s_waitcnt vmcnt(32)
    buffer_load_dwordx4 v3, s[36:39], s42 offen lds
    s_add_u32 s42, s42, 1024
    s_mov_b32 m0, 109056
    s_waitcnt vmcnt(32)
    buffer_load_dwordx4 v3, s[52:55], s43 offen nt lds
    s_add_u32 s43, s43, 1024
    s_mov_b32 m0, 34320
    s_waitcnt vmcnt(32)
    buffer_load_dwordx4 v3, s[36:39], s42 offen lds
    s_add_u32 s42, s42, 1024
    s_mov_b32 m0, 110080
    s_waitcnt vmcnt(32)
    buffer_load_dwordx4 v3, s[52:55], s43 offen nt lds
    s_add_u32 s43, s43, 1024
    s_mov_b32 m0, 35360
    s_waitcnt vmcnt(32)
    buffer_load_dwordx4 v3, s[36:39], s42 offen lds
    s_add_u32 s42, s42, 1024
    s_mov_b32 m0, 111104
    s_waitcnt vmcnt(32)
    buffer_load_dwordx4 v3, s[52:55], s43 offen nt lds
    s_add_u32 s43, s43, 1024
    s_mov_b32 m0, 36400
    s_waitcnt vmcnt(32)
    buffer_load_dwordx4 v3, s[36:39], s42 offen lds
    s_add_u32 s42, s42, 1024
    s_mov_b32 m0, 112128
    s_waitcnt vmcnt(32)
    buffer_load_dwordx4 v3, s[52:55], s43 offen nt lds
    s_add_u32 s43, s43, 1024
    s_mov_b32 m0, 37440
    s_waitcnt vmcnt(32)
    buffer_load_dwordx4 v3, s[36:39], s42 offen lds
    s_add_u32 s42, s42, 1024
    s_mov_b32 m0, 113152
    s_waitcnt vmcnt(32)
    buffer_load_dwordx4 v3, s[52:55], s43 offen nt lds
    s_add_u32 s43, s43, 1024
    s_mov_b32 m0, 38480
    s_waitcnt vmcnt(32)
    buffer_load_dwordx4 v3, s[36:39], s42 offen lds
    s_add_u32 s42, s42, 1024
    s_mov_b32 m0, 114176
    s_waitcnt vmcnt(32)
    buffer_load_dwordx4 v3, s[52:55], s43 offen nt lds
    s_add_u32 s43, s43, 1024
    s_mov_b32 m0, 39520
    s_waitcnt vmcnt(32)
    buffer_load_dwordx4 v3, s[36:39], s42 offen lds
    s_add_u32 s42, s42, 1024
    s_mov_b32 m0, 115200
    s_waitcnt vmcnt(32)
    buffer_load_dwordx4 v3, s[52:55], s43 offen nt lds
    s_add_u32 s43, s43, 1024
    s_mov_b32 m0, 40560
    s_waitcnt vmcnt(32)
    v_mov_b32 v6, 63
    ds_write_b32 v36, v6 offset:0
    buffer_load_dwordx4 v3, s[36:39], s42 offen lds
    s_add_u32 s42, s42, 1024
    s_mov_b32 m0, 116224
    s_waitcnt vmcnt(32)
    buffer_load_dwordx4 v3, s[52:55], s43 offen nt lds
    s_add_u32 s43, s43, 1024
    s_mov_b32 m0, 41600
    s_waitcnt vmcnt(32)
    buffer_load_dwordx4 v3, s[36:39], s42 offen lds
    s_add_u32 s42, s42, 1024
    s_mov_b32 m0, 117248
    s_waitcnt vmcnt(32)
    buffer_load_dwordx4 v3, s[52:55], s43 offen nt lds
    s_add_u32 s43, s43, 1024
    s_mov_b32 m0, 42640
    s_waitcnt vmcnt(32)
    buffer_load_dwordx4 v3, s[36:39], s42 offen lds
    s_add_u32 s42, s42, 1024
    s_mov_b32 m0, 118272
    s_waitcnt vmcnt(32)
    buffer_load_dwordx4 v3, s[52:55], s43 offen nt lds
    s_add_u32 s43, s43, 1024
    s_mov_b32 m0, 43680
    s_waitcnt vmcnt(32)
    buffer_load_dwordx4 v3, s[36:39], s42 offen lds
    s_add_u32 s42, s42, 1024
    s_mov_b32 m0, 119296
    s_waitcnt vmcnt(32)
    buffer_load_dwordx4 v3, s[52:55], s43 offen nt lds
    s_add_u32 s43, s43, 1024
    s_mov_b32 m0, 44720
    s_waitcnt vmcnt(32)
    buffer_load_dwordx4 v3, s[36:39], s42 offen lds
    s_add_u32 s42, s42, 1024
    s_mov_b32 m0, 120320
    s_waitcnt vmcnt(32)
    buffer_load_dwordx4 v8, s[52:55], s43 offen nt lds
    s_add_u32 s43, s43, 1024
    s_mov_b32 m0, 45760
    s_waitcnt vmcnt(32)
    buffer_load_dwordx4 v3, s[36:39], s42 offen lds
    s_add_u32 s42, s42, 1024
    s_mov_b32 m0, 46800
    s_waitcnt vmcnt(32)
    buffer_load_dwordx4 v3, s[36:39], s42 offen lds
    s_add_u32 s42, s42, 1024
    s_mov_b32 m0, 47840
    s_waitcnt vmcnt(32)
    buffer_load_dwordx4 v3, s[36:39], s42 offen lds
    s_add_u32 s42, s42, 1024
    s_mov_b32 m0, 48880
    s_waitcnt vmcnt(32)
    buffer_load_dwordx4 v3, s[36:39], s42 offen lds
    s_add_u32 s42, s42, 246784
    s_mov_b32 m0, 49920
WF_11:
    ds_read_b32 v37, v36 offset:44
    s_sub_u32 s57, s57, 1
    s_cbranch_scc1 L_end
    s_waitcnt lgkmcnt(0)
    v_readfirstlane_b32 s40, v37
    s_nop 0
    s_cmp_lt_u32 s40, 1
    s_cbranch_scc1 WF_11
    s_waitcnt vmcnt(32)
    v_mov_b32 v6, 77
    ds_write_b32 v36, v6 offset:0
    buffer_load_dwordx4 v3, s[36:39], s42 offen lds
    s_add_u32 s42, s42, 1024
    s_add_u32 m0, m0, 1040
    s_waitcnt vmcnt(32)
    buffer_load_dwordx4 v3, s[36:39], s42 offen lds
    s_add_u32 s42, s42, 1024
    s_add_u32 m0, m0, 1040
    s_waitcnt vmcnt(32)
    buffer_load_dwordx4 v3, s[36:39], s42 offen lds
    s_add_u32 s42, s42, 1024
    s_add_u32 m0, m0, 1040
    s_waitcnt vmcnt(32)
    buffer_load_dwordx4 v3, s[36:39], s42 offen lds
    s_add_u32 s42, s42, 1024
    s_add_u32 m0, m0, 1040
    s_waitcnt vmcnt(32)
    buffer_load_dwordx4 v3, s[36:39], s42 offen lds
    s_add_u32 s42, s42, 1024
    s_add_u32 m0, m0, 1040
    s_waitcnt vmcnt(32)
    buffer_load_dwordx4 v3, s[36:39], s42 offen lds
    s_add_u32 s42, s42, 1024
    s_add_u32 m0, m0, 1040
    s_waitcnt vmcnt(32)
    buffer_load_dwordx4 v3, s[36:39], s42 offen lds
    s_add_u32 s42, s42, 1024
    s_add_u32 m0, m0, 1040
    s_waitcnt vmcnt(32)
    buffer_load_dwordx4 v3, s[36:39], s42 offen lds
    s_add_u32 s42, s42, 1024
    s_add_u32 m0, m0, 1040
    s_waitcnt vmcnt(32)
    buffer_load_dwordx4 v3, s[36:39], s42 offen lds
    s_add_u32 s42, s42, 1024
    s_add_u32 m0, m0, 1040
    s_waitcnt vmcnt(32)
    buffer_load_dwordx4 v3, s[36:39], s42 offen lds
    s_add_u32 s42, s42, 1024
    s_add_u32 m0, m0, 1040
    s_waitcnt vmcnt(32)
    buffer_load_dwordx4 v3, s[36:39], s42 offen lds
    s_add_u32 s42, s42, 1024
    s_add_u32 m0, m0, 1040
    s_waitcnt vmcnt(32)
    buffer_load_dwordx4 v3, s[36:39], s42 offen lds
    s_add_u32 s42, s42, 1024
    s_add_u32 m0, m0, 1040
    s_waitcnt vmcnt(32)
    buffer_load_dwordx4 v3, s[36:39], s42 offen lds
    s_add_u32 s42, s42, 1024
    s_add_u32 m0, m0, 1040
    s_waitcnt vmcnt(32)
    buffer_load_dwordx4 v3, s[36:39], s42 offen lds
    s_add_u32 s42, s42, 1024
    s_add_u32 m0, m0, 1040
    s_waitcnt vmcnt(32)
    buffer_load_dwordx4 v3, s[36:39], s42 offen lds
    s_add_u32 s42, s42, 1024
    s_add_u32 m0, m0, 1040
    s_waitcnt vmcnt(32)
    buffer_load_dwordx4 v3, s[36:39], s42 offen lds
    s_add_u32 s42, s42, 246784
    s_add_u32 m0, m0, 1040
WF_12:
    ds_read_b32 v37, v36 offset:8
    s_sub_u32 s57, s57, 1
    s_cbranch_scc1 L_end
    s_waitcnt lgkmcnt(0)
    v_readfirstlane_b32 s40, v37
    s_nop 0
    s_cmp_lt_u32 s40, 1
    s_cbranch_scc1 WF_12
    s_waitcnt vmcnt(32)
    v_mov_b32 v6, 93
    ds_write_b32 v36, v6 offset:0
    buffer_load_dwordx4 v3, s[36:39], s42 offen lds
    s_add_u32 s42, s42, 1024
    s_add_u32 m0, m0, 1040
    s_waitcnt vmcnt(32)
    buffer_load_dwordx4 v3, s[36:39], s42 offen lds
    s_add_u32 s42, s42, 1024
    s_add_u32 m0, m0, 1040
    s_waitcnt vmcnt(32)
    buffer_load_dwordx4 v3, s[36:39], s42 offen lds
    s_add_u32 s42, s42, 1024
    s_add_u32 m0, m0, 1040
    s_waitcnt vmcnt(32)
    buffer_load_dwordx4 v3, s[36:39], s42 offen lds
    s_add_u32 s42, s42, 1024
    s_add_u32 m0, m0, 1040
    s_waitcnt vmcnt(32)
    buffer_load_dwordx4 v3, s[36:39], s42 offen lds
    s_add_u32 s42, s42, 1024
    s_add_u32 m0, m0, 1040
    s_waitcnt vmcnt(32)
    buffer_load_dwordx4 v3, s[36:39], s42 offen lds
    s_add_u32 s42, s42, 1024
    s_add_u32 m0, m0, 1040
    s_waitcnt vmcnt(32)
    buffer_load_dwordx4 v3, s[36:39], s42 offen lds
    s_add_u32 s42, s42, 1024
    s_add_u32 m0, m0, 1040
    s_waitcnt vmcnt(32)
    v_mov_b32 v6, 100
    ds_write_b32 v36, v6 offset:0
    buffer_load_dwordx4 v3, s[36:39], s42 offen lds
    s_add_u32 s42, s42, 1024
    s_add_u32 m0, m0, 1040
    s_waitcnt vmcnt(32)
    buffer_load_dwordx4 v3, s[36:39], s42 offen lds
    s_add_u32 s42, s42, 1024
    s_add_u32 m0, m0, 1040
    s_waitcnt vmcnt(32)
    buffer_load_dwordx4 v3, s[36:39], s42 offen lds
    s_add_u32 s42, s42, 1024
    s_add_u32 m0, m0, 1040
    s_waitcnt vmcnt(32)
    buffer_load_dwordx4 v3, s[36:39], s42 offen lds
    s_add_u32 s42, s42, 1024
    s_add_u32 m0, m0, 1040
    s_waitcnt vmcnt(32)
    buffer_load_dwordx4 v3, s[36:39], s42 offen lds
    s_add_u32 s42, s42, 1024
    s_add_u32 m0, m0, 1040
    s_waitcnt vmcnt(32)
    v_mov_b32 v6, 105
    ds_write_b32 v36, v6 offset:0
    buffer_load_dwordx4 v3, s[36:39], s42 offen lds
    s_add_u32 s42, s42, 1024
    s_add_u32 m0, m0, 1040
    s_waitcnt vmcnt(32)
    buffer_load_dwordx4 v3, s[36:39], s42 offen lds
    s_add_u32 s42, s42, 1024
    s_add_u32 m0, m0, 1040
    s_waitcnt vmcnt(32)
    buffer_load_dwordx4 v3, s[36:39], s42 offen lds
    s_add_u32 s42, s42, 1024
    s_add_u32 m0, m0, 1040
    s_waitcnt vmcnt(32)
    buffer_load_dwordx4 v3, s[36:39], s42 offen lds
    s_add_u32 s42, s42, 246784
    s_add_u32 m0, m0, 1040
    s_waitcnt vmcnt(32)
    v_mov_b32 v6, 109
    ds_write_b32 v36, v6 offset:0
    buffer_load_dwordx4 v3, s[36:39], s42 offen lds
    s_add_u32 s42, s42, 1024
    s_add_u32 m0, m0, 1040
    s_waitcnt vmcnt(32)
    buffer_load_dwordx4 v3, s[36:39], s42 offen lds
    s_add_u32 s42, s42, 1024
    s_add_u32 m0, m0, 1040
    s_waitcnt vmcnt(32)
    buffer_load_dwordx4 v3, s[36:39], s42 offen lds
    s_add_u32 s42, s42, 1024
    s_add_u32 m0, m0, 1040
    s_waitcnt vmcnt(32)
    buffer_load_dwordx4 v3, s[36:39], s42 offen lds
    s_add_u32 s42, s42, 1024
    s_add_u32 m0, m0, 1040
    s_waitcnt vmcnt(32)
    buffer_load_dwordx4 v3, s[36:39], s42 offen lds
    s_add_u32 s42, s42, 1024
    s_add_u32 m0, m0, 1040
    s_waitcnt vmcnt(32)
    buffer_load_dwordx4 v3, s[36:39], s42 offen lds
    s_add_u32 s42, s42, 1024
    s_add_u32 m0, m0, 1040
    s_waitcnt vmcnt(32)
    buffer_load_dwordx4 v3, s[36:39], s42 offen lds
    s_add_u32 s42, s42, 1024
    s_add_u32 m0, m0, 1040
    s_waitcnt vmcnt(32)
    buffer_load_dwordx4 v3, s[36:39], s42 offen lds
    s_add_u32 s42, s42, 1024
    s_add_u32 m0, m0, 1040
    s_waitcnt vmcnt(32)
    buffer_load_dwordx4 v3, s[36:39], s42 offen lds
    s_add_u32 s42, s42, 1024
    s_add_u32 m0, m0, 1040
    s_waitcnt vmcnt(32)
    buffer_load_dwordx4 v3, s[36:39], s42 offen lds
    s_add_u32 s42, s42, 1024
    s_add_u32 m0, m0, 1040
    s_waitcnt vmcnt(32)
    buffer_load_dwordx4 v3, s[36:39], s42 offen lds
    s_add_u32 s42, s42, 1024
    s_add_u32 m0, m0, 1040
    s_waitcnt vmcnt(32)
    buffer_load_dwordx4 v3, s[36:39], s42 offen lds
    s_add_u32 s42, s42, 1024
    s_add_u32 m0, m0, 1040
    s_waitcnt vmcnt(32)
    buffer_load_dwordx4 v3, s[36:39], s42 offen lds
    s_add_u32 s42, s42, 1024
    s_add_u32 m0, m0, 1040
    s_waitcnt vmcnt(32)
    buffer_load_dwordx4 v3, s[36:39], s42 offen lds
    s_add_u32 s42, s42, 1024
    s_add_u32 m0, m0, 1040
    s_waitcnt vmcnt(32)
    buffer_load_dwordx4 v3, s[36:39], s42 offen lds
    s_add_u32 s42, s42, 1024
    s_add_u32 m0, m0, 1040
    s_waitcnt vmcnt(32)
    buffer_load_dwordx4 v3, s[36:39], s42 offen lds
    s_add_u32 s42, s42, 246784
    s_add_u32 m0, m0, 1040
WF_13:
    ds_read_b32 v37, v36 offset:24
    s_sub_u32 s57, s57, 1
    s_cbranch_scc1 L_end
    s_waitcnt lgkmcnt(0)
    v_readfirstlane_b32 s40, v37
    s_nop 0
    s_cmp_lt_u32 s40, 1
    s_cbranch_scc1 WF_13
    s_mov_b32 s46, 125
T_14:
    s_waitcnt vmcnt(32)
    v_mov_b32 v6, s46
    ds_write_b32 v36, v6 offset:0
    buffer_load_dwordx4 v3, s[36:39], s42 offen lds
    s_add_u32 s42, s42, 1024
    s_add_u32 m0, m0, 1040
    s_waitcnt vmcnt(32)
    buffer_load_dwordx4 v3, s[36:39], s42 offen lds
    s_add_u32 s42, s42, 1024
    s_add_u32 m0, m0, 1040
    s_waitcnt vmcnt(32)
    buffer_load_dwordx4 v3, s[36:39], s42 offen lds
    s_add_u32 s42, s42, 1024
    s_add_u32 m0, m0, 1040
    s_waitcnt vmcnt(32)
    buffer_load_dwordx4 v3, s[36:39], s42 offen lds
    s_add_u32 s42, s42, 1024
    s_add_u32 m0, m0, 1040
    s_waitcnt vmcnt(32)
    buffer_load_dwordx4 v3, s[36:39], s42 offen lds
    s_add_u32 s42, s42, 1024
    s_add_u32 m0, m0, 1040
    s_waitcnt vmcnt(32)
    buffer_load_dwordx4 v3, s[36:39], s42 offen lds
    s_add_u32 s42, s42, 1024
    s_add_u32 m0, m0, 1040
    s_waitcnt vmcnt(32)
    buffer_load_dwordx4 v3, s[36:39], s42 offen lds
    s_add_u32 s42, s42, 1024
    s_add_u32 m0, m0, 1040
    s_waitcnt vmcnt(32)
    buffer_load_dwordx4 v3, s[36:39], s42 offen lds
    s_add_u32 s42, s42, 1024
    s_add_u32 m0, m0, 1040
    s_waitcnt vmcnt(32)
    buffer_load_dwordx4 v3, s[36:39], s42 offen lds
    s_add_u32 s42, s42, 1024
    s_add_u32 m0, m0, 1040
    s_waitcnt vmcnt(32)
    buffer_load_dwordx4 v3, s[36:39], s42 offen lds
    s_add_u32 s42, s42, 1024
    s_add_u32 m0, m0, 1040
    s_waitcnt vmcnt(32)
    buffer_load_dwordx4 v3, s[36:39], s42 offen lds
    s_add_u32 s42, s42, 1024
    s_add_u32 m0, m0, 1040
    s_waitcnt vmcnt(32)
    buffer_load_dwordx4 v3, s[36:39], s42 offen lds
    s_add_u32 s42, s42, 1024
    s_add_u32 m0, m0, 1040
    s_waitcnt vmcnt(32)
    buffer_load_dwordx4 v3, s[36:39], s42 offen lds
    s_add_u32 s42, s42, 1024
    s_add_u32 m0, m0, 1040
    s_waitcnt vmcnt(32)
    buffer_load_dwordx4 v3, s[36:39], s42 offen lds
    s_add_u32 s42, s42, 1024
    s_add_u32 m0, m0, 1040
    s_waitcnt vmcnt(32)
    buffer_load_dwordx4 v3, s[36:39], s42 offen lds
    s_add_u32 s42, s42, 1024
    s_add_u32 m0, m0, 1040
    s_waitcnt vmcnt(32)
    buffer_load_dwordx4 v3, s[36:39], s42 offen lds
    s_add_u32 s42, s42, 246784
    s_add_u32 m0, m0, 1040
    s_add_u32 s46, s46, 16
    s_cmp_lt_u32 s46, 157
    s_cbranch_scc1 T_14
    s_lshl_b32 s46, s100, 2
    s_add_u32 s46, s46, 3
    s_add_u32 s46, s46, s97
    s_and_b32 s46, s46, 15
    s_lshl_b32 s46, s46, 14
    s_lshl_b32 s47, s96, 21
    s_add_u32 s46, s46, s47
    v_lshlrev_b32 v12, 7, v0
    s_add_u32 s47, s46, 1835008
    buffer_load_dword v13, v12, s[36:39], s47 offen
    s_add_u32 s47, s46, 1843200
    buffer_load_dword v13, v12, s[36:39], s47 offen
    s_waitcnt lgkmcnt(0)
    s_add_u32 s56, s56, 2654435769
    s_bfe_u32 s58, s56, 524288
    s_bfe_u32 s59, s56, 524296
    s_bfe_u32 s60, s56, 524304
    s_bfe_u32 s61, s56, 524312
    v_lshlrev_b32 v5, 2, v2
    v_add_u32 v5, 156224, v5
    v_add_u32 v37, 149760, v3
    v_mov_b32 v10, s56
    v_mov_b32 v11, s56
    s_lshl_b32 s45, s100, 15
    s_lshl_b32 s46, s101, 8
    s_add_u32 s46, s45, s46
    s_add_u32 s46, s46, 458752
    v_mov_b32 v60, 0x3f803f80
    v_mov_b32 v61, 0x3f803f80
    v_mov_b32 v62, 0x3f803f80
    v_mov_b32 v63, 0x3f803f80
    s_barrier
    ds_read_b32 v8, v5
    s_waitcnt lgkmcnt(0)
    s_barrier
    v_mov_b32 v6, 157
    s_waitcnt vmcnt(34)
    ds_write_b32 v36, v6 offset:0
    v_mov_b32 v6, 173
    s_waitcnt vmcnt(18)
    ds_write_b32 v36, v6 offset:0
    buffer_load_dwordx4 v[88:91], v4, s[32:35], s44 offen nt
    s_add_u32 s44, s44, 32768
    buffer_load_dwordx4 v[92:95], v4, s[32:35], s44 offen nt
    s_add_u32 s44, s44, 32768
    buffer_load_dwordx4 v[96:99], v4, s[32:35], s44 offen nt
    s_add_u32 s44, s44, 32768
    buffer_load_dwordx4 v[100:103], v4, s[32:35], s44 offen nt
    s_add_u32 s44, s44, 32768
    buffer_load_dwordx4 v[104:107], v4, s[32:35], s44 offen nt
    s_add_u32 s44, s44, 32768
    buffer_load_dwordx4 v[108:111], v4, s[32:35], s44 offen nt
    s_add_u32 s44, s44, 32768
    buffer_load_dwordx4 v[112:115], v4, s[32:35], s44 offen nt
    s_add_u32 s44, s44, 32768
    buffer_load_dwordx4 v[116:119], v4, s[32:35], s44 offen nt
    s_add_u32 s44, s44, 32768
    v_mov_b32 v6, 189
    s_waitcnt vmcnt(10)
    ds_write_b32 v36, v6 offset:0
    buffer_load_dwordx4 v[120:123], v4, s[32:35], s44 offen nt
    s_add_u32 s44, s44, 32768
    buffer_load_dwordx4 v[124:127], v4, s[32:35], s44 offen nt
    s_add_u32 s44, s44, 32768
    buffer_load_dwordx4 v[128:131], v4, s[32:35], s44 offen nt
    s_add_u32 s44, s44, 32768
    buffer_load_dwordx4 v[132:135], v4, s[32:35], s44 offen nt
    s_add_u32 s44, s44, 32768
    buffer_load_dwordx4 v[136:139], v4, s[32:35], s44 offen nt
    s_add_u32 s44, s44, 32768
    buffer_load_dwordx4 v[140:143], v4, s[32:35], s44 offen nt
    s_add_u32 s44, s44, 32768
    buffer_load_dwordx4 v[144:147], v4, s[32:35], s44 offen nt
    s_add_u32 s44, s44, 32768
    buffer_load_dwordx4 v[148:151], v4, s[32:35], s44 offen nt
    s_add_u32 s44, s44, 32768
    ds_read_b128 v[72:75], v37 offset:0
    ds_read_b128 v[76:79], v37 offset:1024
    s_waitcnt lgkmcnt(1)
    v_mfma_f32_16x16x32_bf16 v[68:71], v[60:63], v[72:75], 0
    s_waitcnt lgkmcnt(0)
    v_mfma_f32_16x16x32_bf16 v[68:71], v[60:63], v[76:79], v[68:71]
    s_barrier
    ds_read_b32 v6, v36 offset:48
L_w1p:
    ds_read_b128 v[80:83], v37 offset:2048
    ds_read_b128 v[84:87], v37 offset:3072
    s_waitcnt lgkmcnt(2)
    v_readfirstlane_b32 s40, v6
    s_nop 0
    s_cmp_lg_u32 s40, 0
    s_cbranch_scc1 L_w1s
    s_waitcnt lgkmcnt(0)
    v_mfma_f32_16x16x32_bf16 v[68:71], v[60:63], v[80:83], v[68:71]
    v_mfma_f32_16x16x32_bf16 v[68:71], v[60:63], v[84:87], v[68:71]
    v_ceil_f32 v8, v8
    s_nop 6
    v_mov_b32 v9, v68
    s_mov_b64 exec, 0xffff
    buffer_store_dwordx4 v[8:11], v3, s[92:95], s46 offen sc1
    s_mov_b64 exec, -1
    s_setprio 0
    s_barrier
    s_waitcnt vmcnt(1)
    ds_write_b128 v3, v[88:91] offset:0
    ds_write_b128 v3, v[92:95] offset:1040
    ds_write_b128 v3, v[96:99] offset:2080
    ds_write_b128 v3, v[100:103] offset:3120
    ds_write_b128 v3, v[104:107] offset:4160
    ds_write_b128 v3, v[108:111] offset:5200
    ds_write_b128 v3, v[112:115] offset:6240
    ds_write_b128 v3, v[116:119] offset:7280
    ds_write_b128 v3, v[120:123] offset:8320
    ds_write_b128 v3, v[124:127] offset:9360
    ds_write_b128 v3, v[128:131] offset:10400
    ds_write_b128 v3, v[132:135] offset:11440
    ds_write_b128 v3, v[136:139] offset:12480
    ds_write_b128 v3, v[140:143] offset:13520
    ds_write_b128 v3, v[144:147] offset:14560
    ds_write_b128 v3, v[148:151] offset:15600
    ds_write_b32 v36, v38 offset:28
    s_branch L_end
L_w1s:
    ds_read_b32 v14, v5
    s_waitcnt lgkmcnt(0)
    v_ceil_f32 v8, v8
    v_ceil_f32 v14, v14
    v_sub_f32 v8, v8, v14
    v_exp_f32 v15, v8
    v_mov_b32 v8, v14
    v_mul_f32 v68, v68, v15
    v_mul_f32 v69, v69, v15
    v_mul_f32 v70, v70, v15
    v_mul_f32 v71, v71, v15
WF_15:
    ds_read_b32 v6, v36 offset:52
    s_sub_u32 s57, s57, 1
    s_cbranch_scc1 L_end
    s_waitcnt lgkmcnt(0)
    v_readfirstlane_b32 s40, v6
    s_nop 0
    s_cmp_lt_u32 s40, 4
    s_cbranch_scc1 WF_15
    v_mov_b32 v6, 0
    s_branch L_w1p
L_w3:
    s_lshl_b32 s53, s98, 3
    s_add_u32 s53, s53, s99
    s_lshl_b32 s44, s53, 9
    s_add_u32 s44, s44, 16842752
    s_mul_i32 s54, s53, 1152
    s_add_u32 s54, s54, 17825792
    v_lshlrev_b32 v37, 7, v0
    s_mov_b64 exec, 15
    buffer_load_dword v39, v37, s[92:95], s44 offen sc1
    s_mov_b64 exec, 0x1ff
    buffer_load_dword v39, v37, s[92:95], s54 offen sc1
    s_mov_b64 exec, -1
    s_waitcnt lgkmcnt(0)
    s_add_u32 s56, s56, 2654435769
    s_bfe_u32 s58, s56, 524288
    s_bfe_u32 s59, s56, 524296
    s_bfe_u32 s60, s56, 524304
    s_bfe_u32 s61, s56, 524312
    s_mov_b32 s36, s20
    s_and_b32 s37, s21, 0xffff
    s_mov_b32 s38, 9216
    s_mov_b32 s39, 0x20000
    v_and_b32 v24, 1, v0
    v_lshlrev_b32 v24, 4, v24
    v_mov_b32 v25, 0xffff
    v_lshlrev_b32 v24, v24, v25
    v_bfe_u32 v25, v0, 1, 2
    v_cmp_eq_u32 vcc, 0, v25
    s_nop 1
    v_cndmask_b32 v60, 0, v24, vcc
    v_cmp_eq_u32 vcc, 1, v25
    s_nop 1
    v_cndmask_b32 v61, 0, v24, vcc
    v_cmp_eq_u32 vcc, 2, v25
    s_nop 1
    v_cndmask_b32 v62, 0, v24, vcc
    v_cmp_eq_u32 vcc, 3, v25
    s_nop 1
    v_cndmask_b32 v63, 0, v24, vcc
    s_getreg_b32 s43, hwreg(HW_REG_XCC_ID, 0, 3)
    s_and_b32 s55, s56, 0xfff
    s_xor_b32 s55, s55, s43
    s_xor_b32 s52, s54, 16777216
    s_mov_b32 s47, 0
    v_mul_u32_u24 v9, 5, v1
    v_min_u32 v9, 13, v9
    v_lshlrev_b32 v10, 1, v9
    s_mul_i32 s45, s53, 36
    buffer_load_ushort v40, v10, s[36:39], s45 offen offset:0
    buffer_load_ushort v41, v10, s[36:39], s45 offen offset:2
    buffer_load_ushort v42, v10, s[36:39], s45 offen offset:4
    buffer_load_ushort v43, v10, s[36:39], s45 offen offset:6
    buffer_load_ushort v44, v10, s[36:39], s45 offen offset:8
    v_mul_u32_u24 v11, 1152, v9
    v_lshl_add_u32 v11, v2, 4, v11
    v_add_u32 v11, 99840, v11
    v_and_b32 v66, 7, v0
    v_mul_u32_u24 v66, 1152, v66
    v_bfe_u32 v10, v0, 3, 1
    v_mul_u32_u24 v10, 576, v10
    v_add_u32 v66, v66, v10
    v_lshl_add_u32 v66, v9, 2, v66
    s_mul_i32 s50, s98, 9216
    s_mul_i32 s42, s99, 72
    s_add_u32 s50, s50, s42
    s_add_u32 s50, s50, 17825792
    v_mov_b32 v67, 0x7f000000
    v_cmp_gt_u32 vcc, 8, v2
    v_lshrrev_b32 v64, 2, v0
    v_lshlrev_b32 v64, 14, v64
    v_and_b32 v65, 3, v0
    v_lshl_add_u32 v64, v65, 4, v64
    v_lshrrev_b32 v10, 2, v2
    v_lshl_add_u32 v10, v1, 1, v10
    v_lshlrev_b32 v10, 14, v10
    v_lshl_add_u32 v65, v65, 4, v10
    v_cndmask_b32 v65, v67, v65, vcc
    v_mov_b32 v67, 0xffffff00
    s_lshl_b32 s49, s2, 6
    s_add_u32 s49, s49, 3407872
    s_waitcnt vmcnt(5)
WF_16:
    s_sleep 1
    ds_read_b32 v37, v36 offset:0
    s_sub_u32 s57, s57, 1
    s_cbranch_scc1 L_end
    s_waitcnt lgkmcnt(0)
    v_readfirstlane_b32 s40, v37
    s_nop 0
    s_cmp_lt_u32 s40, 105
    s_cbranch_scc1 WF_16
    ds_read_b128 v[68:71], v11 offset:0
    ds_read_b128 v[72:75], v11 offset:1152
    ds_read_b128 v[76:79], v11 offset:2304
    ds_read_b128 v[80:83], v11 offset:3456
    ds_read_b128 v[84:87], v11 offset:4608
    ds_read_b128 v[88:91], v11 offset:256
    ds_read_b128 v[92:95], v11 offset:1408
    ds_read_b128 v[96:99], v11 offset:2560
    ds_read_b128 v[100:103], v11 offset:3712
    ds_read_b128 v[104:107], v11 offset:4864
    ds_read_b128 v[108:111], v11 offset:512
    ds_read_b128 v[112:115], v11 offset:1664
    ds_read_b128 v[116:119], v11 offset:2816
    ds_read_b128 v[120:123], v11 offset:3968
    ds_read_b128 v[124:127], v11 offset:5120
    ds_read_b128 v[128:131], v11 offset:768
    ds_read_b128 v[132:135], v11 offset:1920
    ds_read_b128 v[136:139], v11 offset:3072
    ds_read_b128 v[140:143], v11 offset:4224
    ds_read_b128 v[144:147], v11 offset:5376
    ds_read_b128 v[148:151], v11 offset:1024
    ds_read_b128 v[152:155], v11 offset:2176
    ds_read_b128 v[156:159], v11 offset:3328
    ds_read_b128 v[160:163], v11 offset:4480
    ds_read_b128 v[164:167], v11 offset:5632
    s_mov_b64 exec, 1
    ds_add_u32 v36, v38 offset:24
    s_mov_b64 exec, -1
WF_17:
    s_sleep 2
    ds_read_b32 v37, v36 offset:0
    s_sub_u32 s57, s57, 1
    s_cbranch_scc1 L_end
    s_waitcnt lgkmcnt(0)
    v_readfirstlane_b32 s40, v37
    s_nop 0
    s_cmp_lt_u32 s40, 125
    s_cbranch_scc1 WF_17
    buffer_load_dwordx4 v[4:7], v66, s[92:95], s50 offen sc1
    buffer_load_dword v8, v66, s[92:95], s50 offen offset:16 sc1
    s_barrier
    s_barrier
    s_barrier
    s_barrier
L_hmw:
    s_waitcnt vmcnt(0)
    v_xor_b32 v4, s55, v4
    v_xor_b32 v5, s55, v5
    v_xor_b32 v6, s55, v6
    v_xor_b32 v7, s55, v7
    v_xor_b32 v8, s55, v8
    v_or3_b32 v9, v4, v5, v6
    v_or3_b32 v9, v9, v7, v8
    v_and_b32 v9, 0xfff, v9
    v_cmp_ne_u32 vcc, 0, v9
    s_cbranch_vccnz L_hmr
    v_add_f32_dpp v4, v4, v4 quad_perm:[1,0,3,2] row_mask:0xf bank_mask:0xf
    v_add_f32_dpp v5, v5, v5 quad_perm:[1,0,3,2] row_mask:0xf bank_mask:0xf
    v_add_f32_dpp v6, v6, v6 quad_perm:[1,0,3,2] row_mask:0xf bank_mask:0xf
    v_add_f32_dpp v7, v7, v7 quad_perm:[1,0,3,2] row_mask:0xf bank_mask:0xf
    v_add_f32_dpp v8, v8, v8 quad_perm:[1,0,3,2] row_mask:0xf bank_mask:0xf
    v_add_f32_dpp v4, v4, v4 quad_perm:[2,3,0,1] row_mask:0xf bank_mask:0xf
    v_add_f32_dpp v5, v5, v5 quad_perm:[2,3,0,1] row_mask:0xf bank_mask:0xf
    v_add_f32_dpp v6, v6, v6 quad_perm:[2,3,0,1] row_mask:0xf bank_mask:0xf
    v_add_f32_dpp v7, v7, v7 quad_perm:[2,3,0,1] row_mask:0xf bank_mask:0xf
    v_add_f32_dpp v8, v8, v8 quad_perm:[2,3,0,1] row_mask:0xf bank_mask:0xf
    v_add_f32_dpp v4, v4, v4 row_half_mirror row_mask:0xf bank_mask:0xf
    v_add_f32_dpp v5, v5, v5 row_half_mirror row_mask:0xf bank_mask:0xf
    v_add_f32_dpp v6, v6, v6 row_half_mirror row_mask:0xf bank_mask:0xf
    v_add_f32_dpp v7, v7, v7 row_half_mirror row_mask:0xf bank_mask:0xf
    v_add_f32_dpp v8, v8, v8 row_half_mirror row_mask:0xf bank_mask:0xf
    v_lshlrev_b32 v40, 16, v40
    v_lshlrev_b32 v41, 16, v41
    v_lshlrev_b32 v42, 16, v42
    v_lshlrev_b32 v43, 16, v43
    v_lshlrev_b32 v44, 16, v44
    v_cvt_pk_bf16_f32 v4, v4, v4
    v_and_b32 v4, 0xffff0000, v4
    v_cvt_pk_bf16_f32 v5, v5, v5
    v_and_b32 v5, 0xffff0000, v5
    v_cvt_pk_bf16_f32 v6, v6, v6
    v_and_b32 v6, 0xffff0000, v6
    v_cvt_pk_bf16_f32 v7, v7, v7
    v_and_b32 v7, 0xffff0000, v7
    v_cvt_pk_bf16_f32 v8, v8, v8
    v_and_b32 v8, 0xffff0000, v8
    v_add_f32 v4, v4, v40
    v_add_f32 v5, v5, v41
    v_add_f32 v6, v6, v42
    v_add_f32 v7, v7, v43
    v_add_f32 v8, v8, v44
    v_cvt_pk_bf16_f32 v4, v4, v4
    v_and_b32 v4, 0xffff0000, v4
    v_cvt_pk_bf16_f32 v5, v5, v5
    v_and_b32 v5, 0xffff0000, v5
    v_cvt_pk_bf16_f32 v6, v6, v6
    v_and_b32 v6, 0xffff0000, v6
    v_cvt_pk_bf16_f32 v7, v7, v7
    v_and_b32 v7, 0xffff0000, v7
    v_cvt_pk_bf16_f32 v8, v8, v8
    v_and_b32 v8, 0xffff0000, v8
    s_mov_b32 s42, 0xbdd2d3e8
    v_mov_b32 v9, 0xc0135761
    v_cmp_gt_u32 vcc, 48, v0
    v_mul_f32 v40, v4, v4
    v_fma_f32 v40, v40, s42, v9
    v_mul_f32 v40, v40, v4
    v_mul_f32 v41, v5, v5
    v_fma_f32 v41, v41, s42, v9
    v_mul_f32 v41, v41, v5
    v_mul_f32 v42, v6, v6
    v_fma_f32 v42, v42, s42, v9
    v_mul_f32 v42, v42, v6
    v_mul_f32 v43, v7, v7
    v_fma_f32 v43, v43, s42, v9
    v_mul_f32 v43, v43, v7
    v_mul_f32 v44, v8, v8
    v_fma_f32 v44, v44, s42, v9
    v_mul_f32 v44, v44, v8
    v_exp_f32 v40, v40
    v_exp_f32 v41, v41
    v_exp_f32 v42, v42
    v_exp_f32 v43, v43
    v_exp_f32 v44, v44
    v_add_f32 v40, 1.0, v40
    v_add_f32 v41, 1.0, v41
    v_add_f32 v42, 1.0, v42
    v_add_f32 v43, 1.0, v43
    v_add_f32 v44, 1.0, v44
    v_rcp_f32 v40, v40
    v_rcp_f32 v41, v41
    v_rcp_f32 v42, v42
    v_rcp_f32 v43, v43
    v_rcp_f32 v44, v44
    v_mul_f32 v4, v4, v40
    v_mul_f32 v5, v5, v41
    v_mul_f32 v6, v6, v42
    v_mul_f32 v7, v7, v43
    v_mul_f32 v8, v8, v44
    v_cndmask_b32 v4, 0, v4, vcc
    v_cndmask_b32 v5, 0, v5, vcc
    v_cvt_pk_bf16_f32 v4, v4, v4
    v_cvt_pk_bf16_f32 v5, v5, v5
    v_cvt_pk_bf16_f32 v6, v6, v6
    v_cvt_pk_bf16_f32 v7, v7, v7
    v_cvt_pk_bf16_f32 v8, v8, v8
    v_and_b32 v12, v4, v60
    v_and_b32 v13, v4, v61
    v_and_b32 v14, v4, v62
    v_and_b32 v15, v4, v63
    v_and_b32 v16, v5, v60
    v_and_b32 v17, v5, v61
    v_and_b32 v18, v5, v62
    v_and_b32 v19, v5, v63
    v_and_b32 v20, v6, v60
    v_and_b32 v21, v6, v61
    v_and_b32 v22, v6, v62
    v_and_b32 v23, v6, v63
    v_and_b32 v24, v7, v60
    v_and_b32 v25, v7, v61
    v_and_b32 v26, v7, v62
    v_and_b32 v27, v7, v63
    v_and_b32 v28, v8, v60
    v_and_b32 v29, v8, v61
    v_and_b32 v30, v8, v62
    v_and_b32 v31, v8, v63
    v_mfma_f32_16x16x32_bf16 v[40:43], v[12:15], v[68:71], 0
    v_mfma_f32_16x16x32_bf16 v[40:43], v[16:19], v[72:75], v[40:43]
    v_mfma_f32_16x16x32_bf16 v[40:43], v[20:23], v[76:79], v[40:43]
    v_mfma_f32_16x16x32_bf16 v[40:43], v[24:27], v[80:83], v[40:43]
    v_mfma_f32_16x16x32_bf16 v[40:43], v[28:31], v[84:87], v[40:43]
    v_mfma_f32_16x16x32_bf16 v[44:47], v[12:15], v[88:91], 0
    v_mfma_f32_16x16x32_bf16 v[44:47], v[16:19], v[92:95], v[44:47]
    v_mfma_f32_16x16x32_bf16 v[44:47], v[20:23], v[96:99], v[44:47]
    v_mfma_f32_16x16x32_bf16 v[44:47], v[24:27], v[100:103], v[44:47]
    v_mfma_f32_16x16x32_bf16 v[44:47], v[28:31], v[104:107], v[44:47]
    v_mfma_f32_16x16x32_bf16 v[48:51], v[12:15], v[108:111], 0
    v_mfma_f32_16x16x32_bf16 v[48:51], v[16:19], v[112:115], v[48:51]
    v_mfma_f32_16x16x32_bf16 v[48:51], v[20:23], v[116:119], v[48:51]
    v_mfma_f32_16x16x32_bf16 v[48:51], v[24:27], v[120:123], v[48:51]
    v_mfma_f32_16x16x32_bf16 v[48:51], v[28:31], v[124:127], v[48:51]
    v_mfma_f32_16x16x32_bf16 v[52:55], v[12:15], v[128:131], 0
    v_mfma_f32_16x16x32_bf16 v[52:55], v[16:19], v[132:135], v[52:55]
    v_mfma_f32_16x16x32_bf16 v[52:55], v[20:23], v[136:139], v[52:55]
    v_mfma_f32_16x16x32_bf16 v[52:55], v[24:27], v[140:143], v[52:55]
    v_mfma_f32_16x16x32_bf16 v[52:55], v[28:31], v[144:147], v[52:55]
    v_mfma_f32_16x16x32_bf16 v[56:59], v[12:15], v[148:151], 0
    v_mfma_f32_16x16x32_bf16 v[56:59], v[16:19], v[152:155], v[56:59]
    v_mfma_f32_16x16x32_bf16 v[56:59], v[20:23], v[156:159], v[56:59]
    v_mfma_f32_16x16x32_bf16 v[56:59], v[24:27], v[160:163], v[56:59]
    v_mfma_f32_16x16x32_bf16 v[56:59], v[28:31], v[164:167], v[56:59]
    v_and_or_b32 v40, v40, v67, s58
    v_and_or_b32 v41, v41, v67, s59
    v_and_or_b32 v42, v42, v67, s60
    v_and_or_b32 v43, v43, v67, s61
    v_and_or_b32 v44, v44, v67, s58
    v_and_or_b32 v45, v45, v67, s59
    v_and_or_b32 v46, v46, v67, s60
    v_and_or_b32 v47, v47, v67, s61
    v_and_or_b32 v48, v48, v67, s58
    v_and_or_b32 v49, v49, v67, s59
    v_and_or_b32 v50, v50, v67, s60
    v_and_or_b32 v51, v51, v67, s61
    v_and_or_b32 v52, v52, v67, s58
    v_and_or_b32 v53, v53, v67, s59
    v_and_or_b32 v54, v54, v67, s60
    v_and_or_b32 v55, v55, v67, s61
    v_and_or_b32 v56, v56, v67, s58
    v_and_or_b32 v57, v57, v67, s59
    v_and_or_b32 v58, v58, v67, s60
    v_and_or_b32 v59, v59, v67, s61
WF_18:
    s_sleep 1
    ds_read_b32 v37, v36 offset:36
    s_sub_u32 s57, s57, 1
    s_cbranch_scc1 L_end
    s_waitcnt lgkmcnt(0)
    v_readfirstlane_b32 s40, v37
    s_nop 0
    s_cmp_lt_u32 s40, 8
    s_cbranch_scc1 WF_18
    buffer_store_dwordx4 v[40:43], v64, s[92:95], s49 offen sc1
    s_add_u32 s49, s49, 262144
    buffer_store_dwordx4 v[44:47], v64, s[92:95], s49 offen sc1
    s_add_u32 s49, s49, 262144
    buffer_store_dwordx4 v[48:51], v64, s[92:95], s49 offen sc1
    s_add_u32 s49, s49, 262144
    buffer_store_dwordx4 v[52:55], v64, s[92:95], s49 offen sc1
    s_add_u32 s49, s49, 262144
    buffer_store_dwordx4 v[56:59], v65, s[92:95], s49 offen sc1
    s_barrier
    s_branch L_end
L_hmr:
    s_sub_u32 s57, s57, 1
    s_cbranch_scc1 L_end
    s_sleep 2
    s_add_u32 s47, s47, 1
    s_cmp_lt_u32 s47, 24
    s_cbranch_scc1 L_hmg
    s_xor_b32 s50, s50, 16777216
    s_xor_b32 s55, s55, s43
WF_19:
    ds_read_b32 v37, v36 offset:32
    s_sub_u32 s57, s57, 1
    s_cbranch_scc1 L_end
    s_waitcnt lgkmcnt(0)
    v_readfirstlane_b32 s40, v37
    s_nop 0
    s_cmp_lt_u32 s40, 1
    s_cbranch_scc1 WF_19
    buffer_load_dwordx4 v[12:15], v3, s[92:95], s54 offen sc1
    buffer_load_dwordx4 v[16:19], v3, s[92:95], s54 offen offset:128 sc1
    s_waitcnt vmcnt(0)
    v_xor_b32 v12, s43, v12
    v_xor_b32 v13, s43, v13
    v_xor_b32 v14, s43, v14
    v_xor_b32 v15, s43, v15
    v_xor_b32 v16, s43, v16
    v_xor_b32 v17, s43, v17
    v_xor_b32 v18, s43, v18
    v_xor_b32 v19, s43, v19
    buffer_store_dwordx4 v[12:15], v3, s[92:95], s52 offen sc1
    buffer_store_dwordx4 v[16:19], v3, s[92:95], s52 offen offset:128 sc1
L_hmg:
    buffer_load_dwordx4 v[4:7], v66, s[92:95], s50 offen sc1
    buffer_load_dword v8, v66, s[92:95], s50 offen offset:16 sc1
    s_branch L_hmw
L_w2:
    s_waitcnt lgkmcnt(0)
    s_add_u32 s56, s56, 2654435769
    s_bfe_u32 s58, s56, 524288
    s_bfe_u32 s59, s56, 524296
    s_bfe_u32 s60, s56, 524304
    s_bfe_u32 s61, s56, 524312
    v_mul_u32_u24 v29, 36, v0
    v_add_u32 v29, 153856, v29
    v_bfe_u32 v30, v0, 3, 1
    v_lshl_add_u32 v30, v30, 5, v1
    s_lshl_b32 s42, s99, 2
    v_add_u32 v30, s42, v30
    v_lshlrev_b32 v30, 2, v30
    v_and_b32 v72, 1, v0
    v_lshlrev_b32 v72, 4, v72
    v_mov_b32 v73, 0xffff
    v_lshlrev_b32 v72, v72, v73
    v_bfe_u32 v73, v0, 1, 2
    v_cmp_eq_u32 vcc, 0, v73
    s_nop 1
    v_cndmask_b32 v68, 0, v72, vcc
    v_cmp_eq_u32 vcc, 1, v73
    s_nop 1
    v_cndmask_b32 v69, 0, v72, vcc
    v_cmp_eq_u32 vcc, 2, v73
    s_nop 1
    v_cndmask_b32 v70, 0, v72, vcc
    v_cmp_eq_u32 vcc, 3, v73
    s_nop 1
    v_cndmask_b32 v71, 0, v72, vcc
WF_20:
    s_sleep 1
    ds_read_b32 v37, v36 offset:20
    s_sub_u32 s57, s57, 1
    s_cbranch_scc1 L_end
    s_waitcnt lgkmcnt(0)
    v_readfirstlane_b32 s40, v37
    s_nop 0
    s_cmp_lt_u32 s40, 1
    s_cbranch_scc1 WF_20
    ds_read2_b32 v[4:5], v29 offset0:0 offset1:1
    ds_read2_b32 v[6:7], v29 offset0:2 offset1:3
    ds_read2_b32 v[8:9], v29 offset0:4 offset1:5
    ds_read2_b32 v[10:11], v29 offset0:6 offset1:7
    ds_read_b32 v12, v29 offset:32
    s_waitcnt lgkmcnt(0)
    v_lshlrev_b32 v80, 16, v4
    v_and_b32 v81, 0xffff0000, v4
    v_lshlrev_b32 v82, 16, v5
    v_and_b32 v83, 0xffff0000, v5
    v_lshlrev_b32 v84, 16, v6
    v_and_b32 v85, 0xffff0000, v6
    v_lshlrev_b32 v86, 16, v7
    v_and_b32 v87, 0xffff0000, v7
    v_lshlrev_b32 v88, 16, v8
    v_and_b32 v89, 0xffff0000, v8
    v_lshlrev_b32 v90, 16, v9
    v_and_b32 v91, 0xffff0000, v9
    v_lshlrev_b32 v92, 16, v10
    v_and_b32 v93, 0xffff0000, v10
    v_lshlrev_b32 v94, 16, v11
    v_and_b32 v95, 0xffff0000, v11
    v_lshlrev_b32 v96, 16, v12
    v_and_b32 v97, 0xffff0000, v12
    v_add_f32 v72, v80, v81
    v_add_f32 v72, v72, v82
    v_add_f32 v72, v72, v83
    v_add_f32 v72, v72, v84
    v_add_f32 v72, v72, v85
    v_add_f32 v72, v72, v86
    v_add_f32 v72, v72, v87
    v_add_f32 v72, v72, v88
    v_add_f32 v72, v72, v89
    v_add_f32 v72, v72, v90
    v_add_f32 v72, v72, v91
    v_add_f32 v72, v72, v92
    v_add_f32 v72, v72, v93
    v_add_f32 v72, v72, v94
    v_add_f32 v72, v72, v95
    v_add_f32 v72, v72, v96
    v_add_f32 v72, v72, v97
    s_nop 1
    v_add_f32_dpp v72, v72, v72 quad_perm:[1,0,3,2] row_mask:0xf bank_mask:0xf
    s_nop 1
    v_add_f32_dpp v72, v72, v72 quad_perm:[2,3,0,1] row_mask:0xf bank_mask:0xf
    s_nop 1
    v_add_f32_dpp v72, v72, v72 row_half_mirror row_mask:0xf bank_mask:0xf
    s_nop 1
    v_add_f32_dpp v72, v72, v72 row_mirror row_mask:0xf bank_mask:0xf
    v_mov_b32 v74, v72
    s_nop 1
    v_permlane16_swap_b32 v72, v74
    v_add_f32 v72, v72, v74
    v_mul_f32 v72, 0x3ae38e39, v72
    v_mov_b32 v73, 0
    v_sub_f32 v74, v80, v72
    v_fmac_f32 v73, v74, v74
    v_sub_f32 v74, v81, v72
    v_fmac_f32 v73, v74, v74
    v_sub_f32 v74, v82, v72
    v_fmac_f32 v73, v74, v74
    v_sub_f32 v74, v83, v72
    v_fmac_f32 v73, v74, v74
    v_sub_f32 v74, v84, v72
    v_fmac_f32 v73, v74, v74
    v_sub_f32 v74, v85, v72
    v_fmac_f32 v73, v74, v74
    v_sub_f32 v74, v86, v72
    v_fmac_f32 v73, v74, v74
    v_sub_f32 v74, v87, v72
    v_fmac_f32 v73, v74, v74
    v_sub_f32 v74, v88, v72
    v_fmac_f32 v73, v74, v74
    v_sub_f32 v74, v89, v72
    v_fmac_f32 v73, v74, v74
    v_sub_f32 v74, v90, v72
    v_fmac_f32 v73, v74, v74
    v_sub_f32 v74, v91, v72
    v_fmac_f32 v73, v74, v74
    v_sub_f32 v74, v92, v72
    v_fmac_f32 v73, v74, v74
    v_sub_f32 v74, v93, v72
    v_fmac_f32 v73, v74, v74
    v_sub_f32 v74, v94, v72
    v_fmac_f32 v73, v74, v74
    v_sub_f32 v74, v95, v72
    v_fmac_f32 v73, v74, v74
    v_sub_f32 v74, v96, v72
    v_fmac_f32 v73, v74, v74
    v_sub_f32 v74, v97, v72
    v_fmac_f32 v73, v74, v74
    s_nop 1
    v_add_f32_dpp v73, v73, v73 quad_perm:[1,0,3,2] row_mask:0xf bank_mask:0xf
    s_nop 1
    v_add_f32_dpp v73, v73, v73 quad_perm:[2,3,0,1] row_mask:0xf bank_mask:0xf
    s_nop 1
    v_add_f32_dpp v73, v73, v73 row_half_mirror row_mask:0xf bank_mask:0xf
    s_nop 1
    v_add_f32_dpp v73, v73, v73 row_mirror row_mask:0xf bank_mask:0xf
    v_mov_b32 v74, v73
    s_nop 1
    v_permlane16_swap_b32 v73, v74
    v_add_f32 v73, v73, v74
    v_mul_f32 v73, 0x3ae38e39, v73
    v_cvt_pk_bf16_f32 v72, v72, v72
    v_and_b32 v72, 0xffff0000, v72
    v_cvt_pk_bf16_f32 v73, v73, v73
    v_and_b32 v73, 0xffff0000, v73
    v_add_f32 v73, 0x3727c5ac, v73
    v_cvt_pk_bf16_f32 v73, v73, v73
    v_and_b32 v73, 0xffff0000, v73
    v_sqrt_f32 v73, v73
    s_nop 0
    v_cvt_pk_bf16_f32 v73, v73, v73
    v_and_b32 v73, 0xffff0000, v73
    v_rcp_f32 v73, v73
    v_readlane_b32 s44, v72, 0
    v_readlane_b32 s45, v72, 32
    v_readlane_b32 s46, v73, 0
    v_readlane_b32 s47, v73, 32
    v_sub_f32 v80, v80, v72
    v_sub_f32 v81, v81, v72
    v_sub_f32 v82, v82, v72
    v_sub_f32 v83, v83, v72
    v_sub_f32 v84, v84, v72
    v_sub_f32 v85, v85, v72
    v_sub_f32 v86, v86, v72
    v_sub_f32 v87, v87, v72
    v_sub_f32 v88, v88, v72
    v_sub_f32 v89, v89, v72
    v_sub_f32 v90, v90, v72
    v_sub_f32 v91, v91, v72
    v_sub_f32 v92, v92, v72
    v_sub_f32 v93, v93, v72
    v_sub_f32 v94, v94, v72
    v_sub_f32 v95, v95, v72
    v_sub_f32 v96, v96, v72
    v_sub_f32 v97, v97, v72
    v_cvt_pk_bf16_f32 v78, v80, v81
    v_lshlrev_b32 v80, 16, v78
    v_and_b32 v81, 0xffff0000, v78
    v_cvt_pk_bf16_f32 v78, v82, v83
    v_lshlrev_b32 v82, 16, v78
    v_and_b32 v83, 0xffff0000, v78
    v_cvt_pk_bf16_f32 v78, v84, v85
    v_lshlrev_b32 v84, 16, v78
    v_and_b32 v85, 0xffff0000, v78
    v_cvt_pk_bf16_f32 v78, v86, v87
    v_lshlrev_b32 v86, 16, v78
    v_and_b32 v87, 0xffff0000, v78
    v_cvt_pk_bf16_f32 v78, v88, v89
    v_lshlrev_b32 v88, 16, v78
    v_and_b32 v89, 0xffff0000, v78
    v_cvt_pk_bf16_f32 v78, v90, v91
    v_lshlrev_b32 v90, 16, v78
    v_and_b32 v91, 0xffff0000, v78
    v_cvt_pk_bf16_f32 v78, v92, v93
    v_lshlrev_b32 v92, 16, v78
    v_and_b32 v93, 0xffff0000, v78
    v_cvt_pk_bf16_f32 v78, v94, v95
    v_lshlrev_b32 v94, 16, v78
    v_and_b32 v95, 0xffff0000, v78
    v_cvt_pk_bf16_f32 v78, v96, v97
    v_lshlrev_b32 v96, 16, v78
    v_and_b32 v97, 0xffff0000, v78
    v_mul_f32 v80, v80, v73
    v_mul_f32 v81, v81, v73
    v_mul_f32 v82, v82, v73
    v_mul_f32 v83, v83, v73
    v_mul_f32 v84, v84, v73
    v_mul_f32 v85, v85, v73
    v_mul_f32 v86, v86, v73
    v_mul_f32 v87, v87, v73
    v_mul_f32 v88, v88, v73
    v_mul_f32 v89, v89, v73
    v_mul_f32 v90, v90, v73
    v_mul_f32 v91, v91, v73
    v_mul_f32 v92, v92, v73
    v_mul_f32 v93, v93, v73
    v_mul_f32 v94, v94, v73
    v_mul_f32 v95, v95, v73
    v_mul_f32 v96, v96, v73
    v_mul_f32 v97, v97, v73
    v_cvt_pk_bf16_f32 v78, v80, v81
    v_lshlrev_b32 v80, 16, v78
    v_and_b32 v81, 0xffff0000, v78
    v_cvt_pk_bf16_f32 v78, v82, v83
    v_lshlrev_b32 v82, 16, v78
    v_and_b32 v83, 0xffff0000, v78
    v_cvt_pk_bf16_f32 v78, v84, v85
    v_lshlrev_b32 v84, 16, v78
    v_and_b32 v85, 0xffff0000, v78
    v_cvt_pk_bf16_f32 v78, v86, v87
    v_lshlrev_b32 v86, 16, v78
    v_and_b32 v87, 0xffff0000, v78
    v_cvt_pk_bf16_f32 v78, v88, v89
    v_lshlrev_b32 v88, 16, v78
    v_and_b32 v89, 0xffff0000, v78
    v_cvt_pk_bf16_f32 v78, v90, v91
    v_lshlrev_b32 v90, 16, v78
    v_and_b32 v91, 0xffff0000, v78
    v_cvt_pk_bf16_f32 v78, v92, v93
    v_lshlrev_b32 v92, 16, v78
    v_and_b32 v93, 0xffff0000, v78
    v_cvt_pk_bf16_f32 v78, v94, v95
    v_lshlrev_b32 v94, 16, v78
    v_and_b32 v95, 0xffff0000, v78
    v_cvt_pk_bf16_f32 v78, v96, v97
    v_lshlrev_b32 v96, 16, v78
    v_and_b32 v97, 0xffff0000, v78
    v_add_f32 v72, v80, v81
    v_add_f32 v72, v72, v82
    v_add_f32 v72, v72, v83
    v_add_f32 v72, v72, v84
    v_add_f32 v72, v72, v85
    v_add_f32 v72, v72, v86
    v_add_f32 v72, v72, v87
    v_add_f32 v72, v72, v88
    v_add_f32 v72, v72, v89
    v_add_f32 v72, v72, v90
    v_add_f32 v72, v72, v91
    v_add_f32 v72, v72, v92
    v_add_f32 v72, v72, v93
    v_add_f32 v72, v72, v94
    v_add_f32 v72, v72, v95
    v_add_f32 v72, v72, v96
    v_add_f32 v72, v72, v97
    s_nop 1
    v_add_f32_dpp v72, v72, v72 quad_perm:[1,0,3,2] row_mask:0xf bank_mask:0xf
    s_nop 1
    v_add_f32_dpp v72, v72, v72 quad_perm:[2,3,0,1] row_mask:0xf bank_mask:0xf
    s_nop 1
    v_add_f32_dpp v72, v72, v72 row_half_mirror row_mask:0xf bank_mask:0xf
    s_nop 1
    v_add_f32_dpp v72, v72, v72 row_mirror row_mask:0xf bank_mask:0xf
    v_mov_b32 v74, v72
    s_nop 1
    v_permlane16_swap_b32 v72, v74
    v_add_f32 v72, v72, v74
    v_mul_f32 v72, 0x3ae38e39, v72
    v_mov_b32 v73, 0
    v_sub_f32 v74, v80, v72
    v_fmac_f32 v73, v74, v74
    v_sub_f32 v74, v81, v72
    v_fmac_f32 v73, v74, v74
    v_sub_f32 v74, v82, v72
    v_fmac_f32 v73, v74, v74
    v_sub_f32 v74, v83, v72
    v_fmac_f32 v73, v74, v74
    v_sub_f32 v74, v84, v72
    v_fmac_f32 v73, v74, v74
    v_sub_f32 v74, v85, v72
    v_fmac_f32 v73, v74, v74
    v_sub_f32 v74, v86, v72
    v_fmac_f32 v73, v74, v74
    v_sub_f32 v74, v87, v72
    v_fmac_f32 v73, v74, v74
    v_sub_f32 v74, v88, v72
    v_fmac_f32 v73, v74, v74
    v_sub_f32 v74, v89, v72
    v_fmac_f32 v73, v74, v74
    v_sub_f32 v74, v90, v72
    v_fmac_f32 v73, v74, v74
    v_sub_f32 v74, v91, v72
    v_fmac_f32 v73, v74, v74
    v_sub_f32 v74, v92, v72
    v_fmac_f32 v73, v74, v74
    v_sub_f32 v74, v93, v72
    v_fmac_f32 v73, v74, v74
    v_sub_f32 v74, v94, v72
    v_fmac_f32 v73, v74, v74
    v_sub_f32 v74, v95, v72
    v_fmac_f32 v73, v74, v74
    v_sub_f32 v74, v96, v72
    v_fmac_f32 v73, v74, v74
    v_sub_f32 v74, v97, v72
    v_fmac_f32 v73, v74, v74
    s_nop 1
    v_add_f32_dpp v73, v73, v73 quad_perm:[1,0,3,2] row_mask:0xf bank_mask:0xf
    s_nop 1
    v_add_f32_dpp v73, v73, v73 quad_perm:[2,3,0,1] row_mask:0xf bank_mask:0xf
    s_nop 1
    v_add_f32_dpp v73, v73, v73 row_half_mirror row_mask:0xf bank_mask:0xf
    s_nop 1
    v_add_f32_dpp v73, v73, v73 row_mirror row_mask:0xf bank_mask:0xf
    v_mov_b32 v74, v73
    s_nop 1
    v_permlane16_swap_b32 v73, v74
    v_add_f32 v73, v73, v74
    v_mul_f32 v73, 0x3ae38e39, v73
    v_cvt_pk_bf16_f32 v72, v72, v72
    v_and_b32 v72, 0xffff0000, v72
    v_cvt_pk_bf16_f32 v73, v73, v73
    v_and_b32 v73, 0xffff0000, v73
    v_add_f32 v73, 0x3727c5ac, v73
    v_cvt_pk_bf16_f32 v73, v73, v73
    v_and_b32 v73, 0xffff0000, v73
    v_sqrt_f32 v73, v73
    s_nop 0
    v_cvt_pk_bf16_f32 v73, v73, v73
    v_and_b32 v73, 0xffff0000, v73
    v_rcp_f32 v73, v73
    v_readlane_b32 s44, v72, 0
    v_readlane_b32 s45, v72, 32
    v_readlane_b32 s46, v73, 0
    v_readlane_b32 s47, v73, 32
    v_sub_f32 v80, v80, v72
    v_sub_f32 v81, v81, v72
    v_sub_f32 v82, v82, v72
    v_sub_f32 v83, v83, v72
    v_sub_f32 v84, v84, v72
    v_sub_f32 v85, v85, v72
    v_sub_f32 v86, v86, v72
    v_sub_f32 v87, v87, v72
    v_sub_f32 v88, v88, v72
    v_sub_f32 v89, v89, v72
    v_sub_f32 v90, v90, v72
    v_sub_f32 v91, v91, v72
    v_sub_f32 v92, v92, v72
    v_sub_f32 v93, v93, v72
    v_sub_f32 v94, v94, v72
    v_sub_f32 v95, v95, v72
    v_sub_f32 v96, v96, v72
    v_sub_f32 v97, v97, v72
    v_cvt_pk_bf16_f32 v78, v80, v81
    v_lshlrev_b32 v80, 16, v78
    v_and_b32 v81, 0xffff0000, v78
    v_cvt_pk_bf16_f32 v78, v82, v83
    v_lshlrev_b32 v82, 16, v78
    v_and_b32 v83, 0xffff0000, v78
    v_cvt_pk_bf16_f32 v78, v84, v85
    v_lshlrev_b32 v84, 16, v78
    v_and_b32 v85, 0xffff0000, v78
    v_cvt_pk_bf16_f32 v78, v86, v87
    v_lshlrev_b32 v86, 16, v78
    v_and_b32 v87, 0xffff0000, v78
    v_cvt_pk_bf16_f32 v78, v88, v89
    v_lshlrev_b32 v88, 16, v78
    v_and_b32 v89, 0xffff0000, v78
    v_cvt_pk_bf16_f32 v78, v90, v91
    v_lshlrev_b32 v90, 16, v78
    v_and_b32 v91, 0xffff0000, v78
    v_cvt_pk_bf16_f32 v78, v92, v93
    v_lshlrev_b32 v92, 16, v78
    v_and_b32 v93, 0xffff0000, v78
    v_cvt_pk_bf16_f32 v78, v94, v95
    v_lshlrev_b32 v94, 16, v78
    v_and_b32 v95, 0xffff0000, v78
    v_cvt_pk_bf16_f32 v78, v96, v97
    v_lshlrev_b32 v96, 16, v78
    v_and_b32 v97, 0xffff0000, v78
    v_mul_f32 v80, v80, v73
    v_mul_f32 v81, v81, v73
    v_mul_f32 v82, v82, v73
    v_mul_f32 v83, v83, v73
    v_mul_f32 v84, v84, v73
    v_mul_f32 v85, v85, v73
    v_mul_f32 v86, v86, v73
    v_mul_f32 v87, v87, v73
    v_mul_f32 v88, v88, v73
    v_mul_f32 v89, v89, v73
    v_mul_f32 v90, v90, v73
    v_mul_f32 v91, v91, v73
    v_mul_f32 v92, v92, v73
    v_mul_f32 v93, v93, v73
    v_mul_f32 v94, v94, v73
    v_mul_f32 v95, v95, v73
    v_mul_f32 v96, v96, v73
    v_mul_f32 v97, v97, v73
    v_cvt_pk_bf16_f32 v80, v80, v80
    v_cvt_pk_bf16_f32 v81, v81, v81
    v_cvt_pk_bf16_f32 v82, v82, v82
    v_cvt_pk_bf16_f32 v83, v83, v83
    v_cvt_pk_bf16_f32 v84, v84, v84
    v_cvt_pk_bf16_f32 v85, v85, v85
    v_cvt_pk_bf16_f32 v86, v86, v86
    v_cvt_pk_bf16_f32 v87, v87, v87
    v_cvt_pk_bf16_f32 v88, v88, v88
    v_cvt_pk_bf16_f32 v89, v89, v89
    v_cvt_pk_bf16_f32 v90, v90, v90
    v_cvt_pk_bf16_f32 v91, v91, v91
    v_cvt_pk_bf16_f32 v92, v92, v92
    v_cvt_pk_bf16_f32 v93, v93, v93
    v_cvt_pk_bf16_f32 v94, v94, v94
    v_cvt_pk_bf16_f32 v95, v95, v95
    v_cvt_pk_bf16_f32 v96, v96, v96
    v_cvt_pk_bf16_f32 v97, v97, v97
    ds_bpermute_b32 v80, v30, v80
    ds_bpermute_b32 v81, v30, v81
    ds_bpermute_b32 v82, v30, v82
    ds_bpermute_b32 v83, v30, v83
    ds_bpermute_b32 v84, v30, v84
    ds_bpermute_b32 v85, v30, v85
    ds_bpermute_b32 v86, v30, v86
    ds_bpermute_b32 v87, v30, v87
    ds_bpermute_b32 v88, v30, v88
    ds_bpermute_b32 v89, v30, v89
    ds_bpermute_b32 v90, v30, v90
    ds_bpermute_b32 v91, v30, v91
    ds_bpermute_b32 v92, v30, v92
    ds_bpermute_b32 v93, v30, v93
    ds_bpermute_b32 v94, v30, v94
    ds_bpermute_b32 v95, v30, v95
    ds_bpermute_b32 v96, v30, v96
    ds_bpermute_b32 v97, v30, v97
    s_getreg_b32 s43, hwreg(HW_REG_XCC_ID, 0, 3)
    s_and_b32 s55, s56, 0xfff
    s_xor_b32 s55, s55, s43
    v_mov_b32 v20, 0xfffff000
    s_lshl_b32 s54, s98, 3
    s_add_u32 s54, s54, s99
    s_mul_i32 s54, s54, 1152
    s_add_u32 s54, s54, 17825792
    v_mul_u32_u24 v29, 6144, v1
    v_lshl_add_u32 v29, v2, 4, v29
    v_add_u32 v29, 66560, v29
    v_lshrrev_b32 v21, 5, v0
    v_mul_u32_u24 v21, 576, v21
    v_lshl_add_u32 v21, v2, 5, v21
    v_and_b32 v22, 1, v1
    v_lshl_add_u32 v21, v22, 4, v21
    v_mov_b32 v22, 0x7f000000
    v_cmp_gt_u32 vcc, 9, v2
    s_nop 1
    v_cndmask_b32 v21, v22, v21, vcc
WF_21:
    s_sleep 1
    ds_read_b32 v37, v36 offset:0
    s_sub_u32 s57, s57, 1
    s_cbranch_scc1 L_end
    s_waitcnt lgkmcnt(0)
    v_readfirstlane_b32 s40, v37
    s_nop 0
    s_cmp_lt_u32 s40, 63
    s_cbranch_scc1 WF_21
    ds_read_b128 v[128:131], v29 offset:0
    ds_read_b128 v[132:135], v29 offset:144
    ds_read_b128 v[136:139], v29 offset:288
    ds_read_b128 v[140:143], v29 offset:432
    ds_read_b128 v[144:147], v29 offset:576
    ds_read_b128 v[148:151], v29 offset:720
    ds_read_b128 v[152:155], v29 offset:1024
    ds_read_b128 v[156:159], v29 offset:1168
    v_and_b32 v4, v80, v68
    v_and_b32 v5, v80, v69
    v_and_b32 v6, v80, v70
    v_and_b32 v7, v80, v71
    s_waitcnt lgkmcnt(7)
    s_nop 0
    v_mfma_f32_16x16x32_bf16 v[40:43], v[4:7], v[128:131], 0
    ds_read_b128 v[128:131], v29 offset:1312
    s_waitcnt lgkmcnt(7)
    v_mfma_f32_16x16x32_bf16 v[44:47], v[4:7], v[132:135], 0
    ds_read_b128 v[132:135], v29 offset:1456
    v_and_b32 v8, v81, v68
    v_and_b32 v9, v81, v69
    v_and_b32 v10, v81, v70
    v_and_b32 v11, v81, v71
    s_waitcnt lgkmcnt(7)
    s_nop 0
    v_mfma_f32_16x16x32_bf16 v[40:43], v[8:11], v[136:139], v[40:43]
    ds_read_b128 v[136:139], v29 offset:1600
    s_waitcnt lgkmcnt(7)
    v_mfma_f32_16x16x32_bf16 v[44:47], v[8:11], v[140:143], v[44:47]
    ds_read_b128 v[140:143], v29 offset:1744
    v_and_b32 v4, v82, v68
    v_and_b32 v5, v82, v69
    v_and_b32 v6, v82, v70
    v_and_b32 v7, v82, v71
    s_waitcnt lgkmcnt(7)
    s_nop 0
    v_mfma_f32_16x16x32_bf16 v[40:43], v[4:7], v[144:147], v[40:43]
    ds_read_b128 v[144:147], v29 offset:2048
    s_waitcnt lgkmcnt(7)
    v_mfma_f32_16x16x32_bf16 v[44:47], v[4:7], v[148:151], v[44:47]
    ds_read_b128 v[148:151], v29 offset:2192
    v_and_b32 v8, v83, v68
    v_and_b32 v9, v83, v69
    v_and_b32 v10, v83, v70
    v_and_b32 v11, v83, v71
    s_waitcnt lgkmcnt(7)
    s_nop 0
    v_mfma_f32_16x16x32_bf16 v[40:43], v[8:11], v[152:155], v[40:43]
    ds_read_b128 v[152:155], v29 offset:2336
    s_waitcnt lgkmcnt(7)
    v_mfma_f32_16x16x32_bf16 v[44:47], v[8:11], v[156:159], v[44:47]
    ds_read_b128 v[156:159], v29 offset:2480
    v_and_b32 v4, v84, v68
    v_and_b32 v5, v84, v69
    v_and_b32 v6, v84, v70
    v_and_b32 v7, v84, v71
    s_waitcnt lgkmcnt(7)
    s_nop 0
    v_mfma_f32_16x16x32_bf16 v[40:43], v[4:7], v[128:131], v[40:43]
    ds_read_b128 v[128:131], v29 offset:2624
    s_waitcnt lgkmcnt(7)
    v_mfma_f32_16x16x32_bf16 v[44:47], v[4:7], v[132:135], v[44:47]
    ds_read_b128 v[132:135], v29 offset:2768
    v_and_b32 v8, v85, v68
    v_and_b32 v9, v85, v69
    v_and_b32 v10, v85, v70
    v_and_b32 v11, v85, v71
    s_waitcnt lgkmcnt(7)
    s_nop 0
    v_mfma_f32_16x16x32_bf16 v[40:43], v[8:11], v[136:139], v[40:43]
    ds_read_b128 v[136:139], v29 offset:3072
    s_waitcnt lgkmcnt(7)
    v_mfma_f32_16x16x32_bf16 v[44:47], v[8:11], v[140:143], v[44:47]
    ds_read_b128 v[140:143], v29 offset:3216
    v_and_b32 v4, v86, v68
    v_and_b32 v5, v86, v69
    v_and_b32 v6, v86, v70
    v_and_b32 v7, v86, v71
    s_waitcnt lgkmcnt(7)
    s_nop 0
    v_mfma_f32_16x16x32_bf16 v[40:43], v[4:7], v[144:147], v[40:43]
    ds_read_b128 v[144:147], v29 offset:3360
    s_waitcnt lgkmcnt(7)
    v_mfma_f32_16x16x32_bf16 v[44:47], v[4:7], v[148:151], v[44:47]
    ds_read_b128 v[148:151], v29 offset:3504
    v_and_b32 v8, v87, v68
    v_and_b32 v9, v87, v69
    v_and_b32 v10, v87, v70
    v_and_b32 v11, v87, v71
    s_waitcnt lgkmcnt(7)
    s_nop 0
    v_mfma_f32_16x16x32_bf16 v[40:43], v[8:11], v[152:155], v[40:43]
    ds_read_b128 v[152:155], v29 offset:3648
    s_waitcnt lgkmcnt(7)
    v_mfma_f32_16x16x32_bf16 v[44:47], v[8:11], v[156:159], v[44:47]
    ds_read_b128 v[156:159], v29 offset:3792
    v_and_b32 v4, v88, v68
    v_and_b32 v5, v88, v69
    v_and_b32 v6, v88, v70
    v_and_b32 v7, v88, v71
    s_waitcnt lgkmcnt(7)
    s_nop 0
    v_mfma_f32_16x16x32_bf16 v[40:43], v[4:7], v[128:131], v[40:43]
    ds_read_b128 v[128:131], v29 offset:4096
    s_waitcnt lgkmcnt(7)
    v_mfma_f32_16x16x32_bf16 v[44:47], v[4:7], v[132:135], v[44:47]
    ds_read_b128 v[132:135], v29 offset:4240
    v_and_b32 v8, v89, v68
    v_and_b32 v9, v89, v69
    v_and_b32 v10, v89, v70
    v_and_b32 v11, v89, v71
    s_waitcnt lgkmcnt(7)
    s_nop 0
    v_mfma_f32_16x16x32_bf16 v[40:43], v[8:11], v[136:139], v[40:43]
    ds_read_b128 v[136:139], v29 offset:4384
    s_waitcnt lgkmcnt(7)
    v_mfma_f32_16x16x32_bf16 v[44:47], v[8:11], v[140:143], v[44:47]
    ds_read_b128 v[140:143], v29 offset:4528
    v_and_b32 v4, v90, v68
    v_and_b32 v5, v90, v69
    v_and_b32 v6, v90, v70
    v_and_b32 v7, v90, v71
    s_waitcnt lgkmcnt(7)
    s_nop 0
    v_mfma_f32_16x16x32_bf16 v[40:43], v[4:7], v[144:147], v[40:43]
    ds_read_b128 v[144:147], v29 offset:4672
    s_waitcnt lgkmcnt(7)
    v_mfma_f32_16x16x32_bf16 v[44:47], v[4:7], v[148:151], v[44:47]
    ds_read_b128 v[148:151], v29 offset:4816
    v_and_b32 v8, v91, v68
    v_and_b32 v9, v91, v69
    v_and_b32 v10, v91, v70
    v_and_b32 v11, v91, v71
    s_waitcnt lgkmcnt(7)
    s_nop 0
    v_mfma_f32_16x16x32_bf16 v[40:43], v[8:11], v[152:155], v[40:43]
    ds_read_b128 v[152:155], v29 offset:5120
    s_waitcnt lgkmcnt(7)
    v_mfma_f32_16x16x32_bf16 v[44:47], v[8:11], v[156:159], v[44:47]
    ds_read_b128 v[156:159], v29 offset:5264
    v_and_b32 v4, v92, v68
    v_and_b32 v5, v92, v69
    v_and_b32 v6, v92, v70
    v_and_b32 v7, v92, v71
    s_waitcnt lgkmcnt(7)
    s_nop 0
    v_mfma_f32_16x16x32_bf16 v[40:43], v[4:7], v[128:131], v[40:43]
    ds_read_b128 v[128:131], v29 offset:5408
    s_waitcnt lgkmcnt(7)
    v_mfma_f32_16x16x32_bf16 v[44:47], v[4:7], v[132:135], v[44:47]
    ds_read_b128 v[132:135], v29 offset:5552
    v_and_b32 v8, v93, v68
    v_and_b32 v9, v93, v69
    v_and_b32 v10, v93, v70
    v_and_b32 v11, v93, v71
    s_waitcnt lgkmcnt(7)
    s_nop 0
    v_mfma_f32_16x16x32_bf16 v[40:43], v[8:11], v[136:139], v[40:43]
    ds_read_b128 v[136:139], v29 offset:5696
    s_waitcnt lgkmcnt(7)
    v_mfma_f32_16x16x32_bf16 v[44:47], v[8:11], v[140:143], v[44:47]
    ds_read_b128 v[140:143], v29 offset:5840
    v_and_b32 v4, v94, v68
    v_and_b32 v5, v94, v69
    v_and_b32 v6, v94, v70
    v_and_b32 v7, v94, v71
    s_waitcnt lgkmcnt(7)
    s_nop 0
    v_mfma_f32_16x16x32_bf16 v[40:43], v[4:7], v[144:147], v[40:43]
    s_waitcnt lgkmcnt(6)
    v_mfma_f32_16x16x32_bf16 v[44:47], v[4:7], v[148:151], v[44:47]
    v_and_b32 v8, v95, v68
    v_and_b32 v9, v95, v69
    v_and_b32 v10, v95, v70
    v_and_b32 v11, v95, v71
    s_waitcnt lgkmcnt(5)
    s_nop 0
    v_mfma_f32_16x16x32_bf16 v[40:43], v[8:11], v[152:155], v[40:43]
    s_waitcnt lgkmcnt(4)
    v_mfma_f32_16x16x32_bf16 v[44:47], v[8:11], v[156:159], v[44:47]
    v_and_b32 v4, v96, v68
    v_and_b32 v5, v96, v69
    v_and_b32 v6, v96, v70
    v_and_b32 v7, v96, v71
    s_waitcnt lgkmcnt(3)
    s_nop 0
    v_mfma_f32_16x16x32_bf16 v[40:43], v[4:7], v[128:131], v[40:43]
    s_waitcnt lgkmcnt(2)
    v_mfma_f32_16x16x32_bf16 v[44:47], v[4:7], v[132:135], v[44:47]
    v_and_b32 v8, v97, v68
    v_and_b32 v9, v97, v69
    v_and_b32 v10, v97, v70
    v_and_b32 v11, v97, v71
    s_waitcnt lgkmcnt(1)
    s_nop 0
    v_mfma_f32_16x16x32_bf16 v[40:43], v[8:11], v[136:139], v[40:43]
    s_waitcnt lgkmcnt(0)
    v_mfma_f32_16x16x32_bf16 v[44:47], v[8:11], v[140:143], v[44:47]
    s_mov_b64 exec, 1
    ds_add_u32 v36, v38 offset:8
    s_mov_b64 exec, -1
    s_nop 2
    v_and_or_b32 v40, v40, v20, s55
    v_and_or_b32 v41, v41, v20, s55
    v_and_or_b32 v42, v42, v20, s55
    v_and_or_b32 v43, v43, v20, s55
    v_and_or_b32 v44, v44, v20, s55
    v_and_or_b32 v45, v45, v20, s55
    v_and_or_b32 v46, v46, v20, s55
    v_and_or_b32 v47, v47, v20, s55
    buffer_store_dwordx4 v[40:43], v21, s[92:95], s54 offen
    buffer_store_dwordx4 v[44:47], v21, s[92:95], s54 offen offset:288
    s_waitcnt vmcnt(0)
    ds_write_b32 v36, v38 offset:32
    s_mov_b32 s32, s24
    s_and_b32 s33, s25, 0xffff
    s_mov_b32 s34, 1152
    s_mov_b32 s35, 0x20000
    v_lshlrev_b32 v4, 7, v0
    s_mov_b64 exec, 0x1ff
    buffer_load_dword v9, v4, s[32:35], 0 offen
    s_branch L_end
L_wa:
    s_sub_u32 s51, s3, 4
    v_lshlrev_b32 v4, 2, v2
    v_add_u32 v4, 156224, v4
    v_mul_u32_u24 v5, 1040, v2
    v_lshl_add_u32 v5, v1, 8, v5
    v_add_u32 v5, 133120, v5
    v_and_b32 v13, 7, v2
    v_lshlrev_b32 v13, 1, v13
    v_lshrrev_b32 v14, 3, v2
    v_or_b32 v13, v13, v14
    v_mul_u32_u24 v6, 1040, v13
    v_lshl_add_u32 v6, v1, 8, v6
    s_mul_i32 s42, s51, 16640
    v_add_u32 v6, s42, v6
    v_bfe_u32 v13, v0, 2, 3
    v_lshlrev_b32 v13, 1, v13
    v_lshrrev_b32 v14, 5, v0
    v_or_b32 v13, v13, v14
    v_mul_u32_u24 v7, 1040, v13
    v_and_b32 v14, 3, v0
    v_lshl_add_u32 v7, v14, 3, v7
    s_lshl_b32 s42, s51, 7
    v_add_u32 v7, s42, v7
    v_add_u32 v8, 66560, v7
    v_lshlrev_b32 v9, 20, v1
    v_lshrrev_b32 v13, 3, v2
    v_lshl_add_u32 v9, v13, 18, v9
    v_and_b32 v13, 7, v0
    v_lshl_add_u32 v9, v13, 4, v9
    v_mov_b32 v12, 156288
    s_lshr_b32 s42, s51, 1
    s_lshl_b32 s42, s42, 10
    s_and_b32 s43, s51, 1
    s_lshl_b32 s43, s43, 3
    s_add_u32 s42, s42, s43
    s_add_u32 s42, s42, 149760
    v_add_u32 v15, s42, v3
    v_add_u32 v16, 149760, v3
    s_lshl_b32 s53, s100, 17
    s_lshl_b32 s43, s51, 14
    s_add_u32 s53, s53, s43
    s_and_b32 s43, s51, 3
    s_xor_b32 s43, s43, s101
    s_lshl_b32 s43, s43, 7
    s_add_u32 s53, s53, s43
    s_add_u32 s53, s53, 8388608
    s_lshl_b32 s45, s98, 3
    s_add_u32 s45, s45, s99
    s_lshl_b32 s46, s45, 14
    s_lshl_b32 s43, s51, 11
    s_add_u32 s46, s46, s43
    s_add_u32 s46, s46, 8388608
    s_lshl_b32 s48, s45, 9
    s_add_u32 s48, s48, 65536
    s_xor_b32 s49, s48, 16777216
    s_mov_b32 s47, 0
    s_lshr_b32 s42, s96, 2
    s_lshl_b32 s42, s42, 15
    s_lshl_b32 s44, s100, 14
    s_add_u32 s42, s42, s44
    s_add_u32 s42, s42, s43
    s_add_u32 s42, s42, 262144
    s_mul_i32 s43, s51, 2080
    s_add_u32 s43, s43, 133120
    v_add_u32 v36, s43, v3
    s_lshr_b32 s54, s51, 1
    s_lshl_b32 s55, s51, 4
    s_add_u32 s55, s55, 77
    s_lshl_b32 s44, s2, 12
    s_lshl_b32 s43, s51, 9
    s_add_u32 s44, s44, s43
    s_add_u32 s44, s44, 1572864
    s_add_u32 s16, s30, s44
    s_addc_u32 s17, s31, 0
    s_mov_b32 s50, 0x42000000
    s_lshl3_add_u32 s44, s100, s51
    s_lshl_b32 s44, s44, 14
    s_lshl3_add_u32 s43, s97, s96
    s_lshr_b32 s43, s43, 2
    s_lshl_b32 s43, s43, 7
    s_add_u32 s44, s44, s43
    s_add_u32 s44, s44, 4718592
    s_add_u32 s18, s30, s44
    s_addc_u32 s19, s31, 0
    s_waitcnt lgkmcnt(0)
    s_add_u32 s56, s56, 2654435769
    s_bfe_u32 s58, s56, 524288
    s_bfe_u32 s59, s56, 524296
    s_bfe_u32 s60, s56, 524304
    s_bfe_u32 s61, s56, 524312
    v_and_b32 v13, 3, v0
    v_lshlrev_b32 v13, 3, v13
    v_lshrrev_b32_e64 v14, v13, s56
    v_bfe_u32 v32, v14, 0, 1
    v_bfe_u32 v13, v14, 1, 1
    v_lshl_or_b32 v32, v13, 16, v32
    v_bfe_u32 v33, v14, 2, 1
    v_bfe_u32 v13, v14, 3, 1
    v_lshl_or_b32 v33, v13, 16, v33
    v_bfe_u32 v34, v14, 4, 1
    v_bfe_u32 v13, v14, 5, 1
    v_lshl_or_b32 v34, v13, 16, v34
    v_bfe_u32 v35, v14, 6, 1
    v_bfe_u32 v13, v14, 7, 1
    v_lshl_or_b32 v35, v13, 16, v35
    v_mov_b32 v10, v32
    v_mov_b32 v11, v33
    v_mov_b32 v17, v34
    v_mov_b32 v19, v35
    v_xor_b32 v32, 0x00010001, v32
    v_xor_b32 v33, 0x00010001, v33
    v_xor_b32 v34, 0x00010001, v34
    v_xor_b32 v35, 0x00010001, v35
WF_22:
    s_sleep 2
    ds_read_b32 v13, v12 offset:0
    s_sub_u32 s57, s57, 1
    s_cbranch_scc1 L_end
    s_waitcnt lgkmcnt(0)
    v_readfirstlane_b32 s40, v13
    s_nop 0
    s_cmp_lt_u32 s40, 100
    s_cbranch_scc1 WF_22
    s_setprio 3
    buffer_load_dwordx4 v[24:27], v3, s[92:95], s42 offen sc1
    buffer_load_dwordx4 v[28:31], v3, s[92:95], s42 offen offset:1024 sc1
    s_setprio 0
    s_load_dword s12, s[18:19], 0 glc
    s_cmp_ge_u32 s2, 72
    s_cbranch_scc1 L_nhs
    s_load_dword s8, s[16:17], 0 glc
    s_load_dword s9, s[16:17], 128 glc
    s_load_dword s10, s[16:17], 256 glc
    s_load_dword s11, s[16:17], 384 glc
L_nhs:
WF_24:
    s_sleep 1
    ds_read_b32 v13, v12 offset:0
    s_sub_u32 s57, s57, 1
    s_cbranch_scc1 L_end
    s_waitcnt lgkmcnt(0)
    v_readfirstlane_b32 s40, v13
    s_nop 0
    s_cmp_lt_u32 s40, 109
    s_cbranch_scc1 WF_24
    ds_read_b64_tr_b16 v[104:105], v7 offset:0
    ds_read_b64_tr_b16 v[106:107], v7 offset:16640
    ds_read_b64_tr_b16 v[108:109], v7 offset:32
    ds_read_b64_tr_b16 v[110:111], v7 offset:16672
    ds_read_b64_tr_b16 v[112:113], v7 offset:64
    ds_read_b64_tr_b16 v[114:115], v7 offset:16704
    ds_read_b64_tr_b16 v[116:117], v7 offset:96
    ds_read_b64_tr_b16 v[118:119], v7 offset:16736
WF_26:
    s_sleep 1
    ds_read_b32 v13, v12 offset:0
    s_sub_u32 s57, s57, 1
    s_cbranch_scc1 L_end
    s_waitcnt lgkmcnt(0)
    v_readfirstlane_b32 s40, v13
    s_nop 0
    s_cmp_lt_u32 s40, 125
    s_cbranch_scc1 WF_26
    ds_read_b64_tr_b16 v[120:121], v7 offset:33280
    ds_read_b64_tr_b16 v[122:123], v7 offset:49920
    ds_read_b64_tr_b16 v[124:125], v7 offset:33312
    ds_read_b64_tr_b16 v[126:127], v7 offset:49952
    ds_read_b64_tr_b16 v[128:129], v7 offset:33344
    ds_read_b64_tr_b16 v[130:131], v7 offset:49984
    ds_read_b64_tr_b16 v[132:133], v7 offset:33376
    ds_read_b64_tr_b16 v[134:135], v7 offset:50016
    s_cmp_ge_u32 s54, 2
    s_cbranch_scc1 L_h2
    ds_read_b128 v[40:43], v6 offset:0
    ds_read_b128 v[44:47], v6 offset:16
    ds_read_b128 v[48:51], v6 offset:32
    ds_read_b128 v[52:55], v6 offset:48
    ds_read_b128 v[56:59], v6 offset:64
    ds_read_b128 v[60:63], v6 offset:80
    ds_read_b128 v[64:67], v6 offset:96
    ds_read_b128 v[68:71], v6 offset:112
    ds_read_b128 v[72:75], v6 offset:128
    ds_read_b128 v[76:79], v6 offset:144
    ds_read_b128 v[80:83], v6 offset:160
    ds_read_b128 v[84:87], v6 offset:176
    ds_read_b128 v[88:91], v6 offset:192
    ds_read_b128 v[92:95], v6 offset:208
    ds_read_b128 v[96:99], v6 offset:224
    ds_read_b128 v[100:103], v6 offset:240
L_h2:
    s_waitcnt vmcnt(1)
    v_xor_b32 v24, v32, v24
    v_xor_b32 v25, v33, v25
    v_xor_b32 v26, v34, v26
    v_xor_b32 v27, v35, v27
    ds_write_b128 v36, v[24:27] offset:0
    v_and_b32 v37, v24, v25
    v_bitop3_b32 v37, v26, v27, v37 bitop3:0x80
    s_waitcnt vmcnt(0)
    v_xor_b32 v28, v32, v28
    v_xor_b32 v29, v33, v29
    v_xor_b32 v30, v34, v30
    v_xor_b32 v31, v35, v31
    ds_write_b128 v36, v[28:31] offset:1040
    v_bitop3_b32 v37, v28, v29, v37 bitop3:0x80
    v_bitop3_b32 v37, v30, v31, v37 bitop3:0x80
    v_bitop3_b32 v37, v37, s63, s63 bitop3:0x03
    v_cmp_ne_u32 vcc, 0, v37
    s_cbranch_vccnz L_h2r
    s_mov_b64 exec, 1
    ds_add_u32 v12, v38 offset:4
    s_mov_b64 exec, -1
WF_27:
    ds_read_b32 v13, v12 offset:4
    s_sub_u32 s57, s57, 1
    s_cbranch_scc1 L_end
    s_waitcnt lgkmcnt(0)
    v_readfirstlane_b32 s40, v13
    s_nop 0
    s_cmp_lt_u32 s40, 8
    s_cbranch_scc1 WF_27
    s_cmp_lt_u32 s54, 2
    s_cbranch_scc1 L_early
    ds_read_b128 v[40:43], v5 offset:0
    ds_read_b128 v[44:47], v5 offset:16
    ds_read_b128 v[48:51], v5 offset:32
    ds_read_b128 v[52:55], v5 offset:48
    ds_read_b128 v[56:59], v5 offset:64
    ds_read_b128 v[60:63], v5 offset:80
    ds_read_b128 v[64:67], v5 offset:96
    ds_read_b128 v[68:71], v5 offset:112
    ds_read_b128 v[72:75], v5 offset:128
    ds_read_b128 v[76:79], v5 offset:144
    ds_read_b128 v[80:83], v5 offset:160
    ds_read_b128 v[84:87], v5 offset:176
    ds_read_b128 v[88:91], v5 offset:192
    ds_read_b128 v[92:95], v5 offset:208
    ds_read_b128 v[96:99], v5 offset:224
    ds_read_b128 v[100:103], v5 offset:240
L_b3:
    s_barrier
    ds_read_b32 v18, v4
    s_setprio 1
    s_cmp_ge_u32 s54, 2
    s_waitcnt lgkmcnt(0)
    v_ceil_f32 v18, v18
    s_cbranch_scc1 L_a2
    v_sub_f32 v20, v20, v18
    v_sub_f32 v21, v21, v18
    v_sub_f32 v22, v22, v18
    v_sub_f32 v23, v23, v18
    v_exp_f32 v20, v20
    v_exp_f32 v21, v21
    v_exp_f32 v22, v22
    v_exp_f32 v23, v23
    v_cvt_pk_bf16_f32 v20, v20, v21
    v_cvt_pk_bf16_f32 v21, v22, v23
    ds_write_b64 v15, v[20:21]
    ds_write_b32 v4, v18 offset:1664
    s_waitcnt lgkmcnt(0)
L_a2:
    s_barrier
    ds_read_b128 v[152:155], v16 offset:0
    ds_read_b128 v[156:159], v16 offset:1024
    s_waitcnt lgkmcnt(1)
    v_mfma_f32_16x16x32_bf16 v[24:27], v[152:155], v[104:107], 0
    v_mfma_f32_16x16x32_bf16 v[28:31], v[152:155], v[108:111], 0
    v_mfma_f32_16x16x32_bf16 v[32:35], v[152:155], v[112:115], 0
    v_mfma_f32_16x16x32_bf16 v[36:39], v[152:155], v[116:119], 0
    s_waitcnt lgkmcnt(0)
    v_mfma_f32_16x16x32_bf16 v[24:27], v[156:159], v[120:123], v[24:27]
    v_mfma_f32_16x16x32_bf16 v[28:31], v[156:159], v[124:127], v[28:31]
    v_mfma_f32_16x16x32_bf16 v[32:35], v[156:159], v[128:131], v[32:35]
    v_mfma_f32_16x16x32_bf16 v[36:39], v[156:159], v[132:135], v[36:39]
    s_cmp_lg_u32 s51, 7
    s_cbranch_scc1 L_n7
    s_setprio 2
WF_28:
    ds_read_b32 v13, v12 offset:0
    s_sub_u32 s57, s57, 1
    s_cbranch_scc1 L_end
    s_waitcnt lgkmcnt(0)
    v_readfirstlane_b32 s40, v13
    s_nop 0
    s_cmp_lt_u32 s40, 157
    s_cbranch_scc1 WF_28
    ds_read_b64_tr_b16 v[136:137], v8 offset:0
    ds_read_b64_tr_b16 v[138:139], v8 offset:16640
    ds_read_b64_tr_b16 v[140:141], v8 offset:32
    ds_read_b64_tr_b16 v[142:143], v8 offset:16672
    ds_read_b64_tr_b16 v[144:145], v8 offset:64
    ds_read_b64_tr_b16 v[146:147], v8 offset:16704
    ds_read_b64_tr_b16 v[148:149], v8 offset:96
    ds_read_b64_tr_b16 v[150:151], v8 offset:16736
WF_29:
    ds_read_b32 v13, v12 offset:0
    s_sub_u32 s57, s57, 1
    s_cbranch_scc1 L_end
    s_waitcnt lgkmcnt(0)
    v_readfirstlane_b32 s40, v13
    s_nop 0
    s_cmp_lt_u32 s40, 189
    s_cbranch_scc1 WF_29
    ds_read_b128 v[104:107], v6 offset:0
    ds_read_b128 v[108:111], v6 offset:16
    ds_read_b128 v[112:115], v6 offset:32
    ds_read_b128 v[116:119], v6 offset:48
    ds_read_b128 v[120:123], v6 offset:64
    ds_read_b128 v[124:127], v6 offset:80
    ds_read_b128 v[128:131], v6 offset:96
    ds_read_b128 v[132:135], v6 offset:112
    s_waitcnt lgkmcnt(7)
    v_mfma_f32_16x16x32_bf16 v[20:23], v[104:107], v[40:43], 0
    ds_read_b128 v[104:107], v6 offset:128
    s_waitcnt lgkmcnt(7)
    v_mfma_f32_16x16x32_bf16 v[20:23], v[108:111], v[44:47], v[20:23]
    ds_read_b128 v[108:111], v6 offset:144
    s_waitcnt lgkmcnt(7)
    v_mfma_f32_16x16x32_bf16 v[20:23], v[112:115], v[48:51], v[20:23]
    ds_read_b128 v[112:115], v6 offset:160
    s_waitcnt lgkmcnt(7)
    v_mfma_f32_16x16x32_bf16 v[20:23], v[116:119], v[52:55], v[20:23]
    ds_read_b128 v[116:119], v6 offset:176
    s_waitcnt lgkmcnt(7)
    v_mfma_f32_16x16x32_bf16 v[20:23], v[120:123], v[56:59], v[20:23]
    ds_read_b128 v[120:123], v6 offset:192
    s_waitcnt lgkmcnt(7)
    v_mfma_f32_16x16x32_bf16 v[20:23], v[124:127], v[60:63], v[20:23]
    ds_read_b128 v[124:127], v6 offset:208
    s_waitcnt lgkmcnt(7)
    v_mfma_f32_16x16x32_bf16 v[20:23], v[128:131], v[64:67], v[20:23]
    ds_read_b128 v[128:131], v6 offset:224
    s_waitcnt lgkmcnt(7)
    v_mfma_f32_16x16x32_bf16 v[20:23], v[132:135], v[68:71], v[20:23]
    ds_read_b128 v[132:135], v6 offset:240
    s_waitcnt lgkmcnt(7)
    v_mfma_f32_16x16x32_bf16 v[20:23], v[104:107], v[72:75], v[20:23]
    ds_read_b64_tr_b16 v[152:153], v8 offset:33280
    s_waitcnt lgkmcnt(7)
    v_mfma_f32_16x16x32_bf16 v[20:23], v[108:111], v[76:79], v[20:23]
    ds_read_b64_tr_b16 v[154:155], v8 offset:49920
    s_waitcnt lgkmcnt(7)
    v_mfma_f32_16x16x32_bf16 v[20:23], v[112:115], v[80:83], v[20:23]
    ds_read_b64_tr_b16 v[156:157], v8 offset:33312
    s_waitcnt lgkmcnt(7)
    v_mfma_f32_16x16x32_bf16 v[20:23], v[116:119], v[84:87], v[20:23]
    ds_read_b64_tr_b16 v[158:159], v8 offset:49952
    s_waitcnt lgkmcnt(7)
    v_mfma_f32_16x16x32_bf16 v[20:23], v[120:123], v[88:91], v[20:23]
    ds_read_b64_tr_b16 v[160:161], v8 offset:33344
    s_waitcnt lgkmcnt(7)
    v_mfma_f32_16x16x32_bf16 v[20:23], v[124:127], v[92:95], v[20:23]
    ds_read_b64_tr_b16 v[162:163], v8 offset:49984
    s_waitcnt lgkmcnt(7)
    v_mfma_f32_16x16x32_bf16 v[20:23], v[128:131], v[96:99], v[20:23]
    ds_read_b64_tr_b16 v[164:165], v8 offset:33376
    s_waitcnt lgkmcnt(7)
    v_mfma_f32_16x16x32_bf16 v[20:23], v[132:135], v[100:103], v[20:23]
    ds_read_b64_tr_b16 v[166:167], v8 offset:50016
    s_nop 6
    v_sub_f32 v40, v20, v18
    v_sub_f32 v41, v21, v18
    v_sub_f32 v42, v22, v18
    v_sub_f32 v43, v23, v18
    v_exp_f32 v40, v40
    v_exp_f32 v41, v41
    v_exp_f32 v42, v42
    v_exp_f32 v43, v43
    v_cvt_pk_bf16_f32 v40, v40, v41
    v_cvt_pk_bf16_f32 v41, v42, v43
    ds_write_b64 v15, v[40:41]
    v_max3_f32 v13, v20, v21, v22
    v_max_f32 v13, v13, v23
    ds_max_f32 v4, v13
    v_sub_f32 v13, v13, v18
    v_cmp_nle_f32 vcc, v13, s50
    s_cbranch_vccnz L_ovf
L_bb:
    s_waitcnt lgkmcnt(0)
    s_barrier
    ds_read_b32 v13, v12 offset:48
L_p3:
    ds_read_b128 v[104:107], v16 offset:2048
    ds_read_b128 v[108:111], v16 offset:3072
    s_setprio 1
    s_waitcnt lgkmcnt(1)
    v_readfirstlane_b32 s40, v13
    s_nop 0
    s_cmp_lg_u32 s40, 0
    s_cbranch_scc1 L_slow
    v_mfma_f32_16x16x32_bf16 v[24:27], v[104:107], v[136:139], v[24:27]
    v_mfma_f32_16x16x32_bf16 v[28:31], v[104:107], v[140:143], v[28:31]
    v_mfma_f32_16x16x32_bf16 v[32:35], v[104:107], v[144:147], v[32:35]
    v_mfma_f32_16x16x32_bf16 v[36:39], v[104:107], v[148:151], v[36:39]
    s_waitcnt lgkmcnt(0)
    v_mfma_f32_16x16x32_bf16 v[24:27], v[108:111], v[152:155], v[24:27]
    v_mfma_f32_16x16x32_bf16 v[28:31], v[108:111], v[156:159], v[28:31]
    v_mfma_f32_16x16x32_bf16 v[32:35], v[108:111], v[160:163], v[32:35]
    v_mfma_f32_16x16x32_bf16 v[36:39], v[108:111], v[164:167], v[36:39]
    s_nop 5
    v_perm_b32 v82, v29, v25, s62
    s_nop 0
    v_perm_b32 v83, v37, v33, s62
    v_perm_b32 v80, v28, v24, s62
    v_perm_b32 v81, v36, v32, s62
    v_mov_b32_dpp v88, v82 row_ror:8 row_mask:0xf bank_mask:0xf
    v_mov_b32_dpp v89, v83 row_ror:8 row_mask:0xf bank_mask:0xf
    v_mov_b32_dpp v82, v80 row_ror:8 row_mask:0xf bank_mask:0x3
    v_mov_b32_dpp v83, v81 row_ror:8 row_mask:0xf bank_mask:0x3
    v_mov_b32_dpp v80, v88 quad_perm:[0,1,2,3] row_mask:0xf bank_mask:0xc
    v_mov_b32_dpp v81, v89 quad_perm:[0,1,2,3] row_mask:0xf bank_mask:0xc
    v_and_or_b32 v82, v82, s63, v17
    v_and_or_b32 v83, v83, s63, v19
    v_and_or_b32 v80, v80, s63, v10
    v_and_or_b32 v81, v81, s63, v11
    buffer_store_dwordx4 v[80:83], v9, s[92:95], s53 offen sc1
    s_add_u32 s53, s53, 524288
    v_perm_b32 v86, v31, v27, s62
    v_perm_b32 v87, v39, v35, s62
    v_perm_b32 v84, v30, v26, s62
    v_perm_b32 v85, v38, v34, s62
    v_mov_b32_dpp v88, v86 row_ror:8 row_mask:0xf bank_mask:0xf
    v_mov_b32_dpp v89, v87 row_ror:8 row_mask:0xf bank_mask:0xf
    v_mov_b32_dpp v86, v84 row_ror:8 row_mask:0xf bank_mask:0x3
    v_mov_b32_dpp v87, v85 row_ror:8 row_mask:0xf bank_mask:0x3
    v_mov_b32_dpp v84, v88 quad_perm:[0,1,2,3] row_mask:0xf bank_mask:0xc
    v_mov_b32_dpp v85, v89 quad_perm:[0,1,2,3] row_mask:0xf bank_mask:0xc
    v_and_or_b32 v86, v86, s63, v17
    v_and_or_b32 v87, v87, s63, v19
    v_and_or_b32 v84, v84, s63, v10
    v_and_or_b32 v85, v85, s63, v11
    buffer_store_dwordx4 v[84:87], v9, s[92:95], s53 offen sc1
    s_barrier
    v_xor_b32 v24, 0x00010001, v10
    v_xor_b32 v25, 0x00010001, v11
    v_xor_b32 v26, 0x00010001, v17
    v_xor_b32 v27, 0x00010001, v19
    v_bfe_u32 v9, v0, 2, 2
    v_lshrrev_b32 v8, 5, v0
    v_mul_u32_u24 v9, 4160, v9
    v_and_b32 v6, 1, v1
    v_lshl_add_u32 v9, v1, 8, v9
    v_and_b32 v13, 3, v0
    v_lshl_add_u32 v9, v13, 3, v9
    s_lshl_b32 s44, s51, 5
    v_add_u32 v9, s44, v9
    v_bfe_u32 v14, v0, 2, 1
    v_lshrrev_b32 v4, 3, v0
    v_lshl_add_u32 v4, v14, 3, v4
    s_and_b32 s44, s99, 3
    v_xor_b32 v4, s44, v4
    v_lshlrev_b32 v4, 8, v4
    v_mov_b32 v62, s56
    v_mov_b32 v11, 1
    s_lshl_b32 s52, s100, 15
    s_lshl_b32 s44, s51, 12
    s_add_u32 s52, s52, s44
    s_lshr_b32 s44, s98, 1
    s_lshl_b32 s44, s44, 4
    s_add_u32 s52, s52, s44
    s_add_u32 s52, s52, 458752
    s_getreg_b32 s43, hwreg(HW_REG_XCC_ID, 0, 3)
    v_cmp_ne_u32 s[14:15], 0, v6
    v_cmp_ne_u32 s[6:7], 0, v14
    v_and_b32 v13, 1, v0
    v_lshlrev_b32 v13, 4, v13
    v_mov_b32 v14, 0xffff
    v_lshlrev_b32 v13, v13, v14
    v_bfe_u32 v14, v0, 1, 2
    v_cmp_eq_u32 vcc, 0, v14
    s_nop 1
    v_cndmask_b32 v20, 0, v13, vcc
    v_cmp_eq_u32 vcc, 1, v14
    s_nop 1
    v_cndmask_b32 v21, 0, v13, vcc
    v_cmp_eq_u32 vcc, 2, v14
    s_nop 1
    v_cndmask_b32 v22, 0, v13, vcc
    v_cmp_eq_u32 vcc, 3, v14
    s_nop 1
    v_cndmask_b32 v23, 0, v13, vcc
    v_and_b32 v13, 3, v0
    v_lshlrev_b32 v13, 3, v13
    v_lshrrev_b32_e64 v17, v13, s56
    v_and_b32 v17, 0xff, v17
    v_xor_b32 v17, s43, v17
    v_bfe_u32 v5, v0, 3, 1
    v_mul_u32_u24 v5, 144, v5
    v_and_b32 v14, 7, v0
    v_lshl_add_u32 v5, v14, 4, v5
    v_lshl_add_u32 v5, v6, 3, v5
    s_mul_i32 s44, s51, 288
    s_add_u32 s44, s44, 153856
    v_add_u32 v5, s44, v5
    v_mul_u32_u24 v7, 144, v2
    v_lshl_add_u32 v7, v1, 4, v7
    v_add_u32 v7, 153856, v7
    v_lshlrev_b32 v10, 6, v8
    v_lshl_add_u32 v10, v2, 2, v10
    s_lshl_b32 s44, s51, 7
    s_add_u32 s44, s44, 158400
    v_add_u32 v10, s44, v10
    v_lshlrev_b32 v15, 4, v8
    v_add_u32 v15, 156160, v15
    s_lshl_b32 s44, s51, 2
    s_add_u32 s44, s44, 156160
    v_mov_b32 v16, s44
    v_lshlrev_b32 v8, 9, v8
    v_lshrrev_b32 v14, 2, v2
    v_lshl_add_u32 v8, v14, 7, v8
    v_and_b32 v14, 3, v0
    v_lshl_add_u32 v8, v14, 2, v8
    s_lshl_b32 s45, s98, 3
    s_add_u32 s45, s45, s51
    s_lshl_b32 s45, s45, 10
    s_lshl_b32 s44, s99, 4
    s_add_u32 s48, s45, s44
    s_add_u32 s48, s48, 17301504
    s_mov_b32 s41, 0xffffff00
    s_mov_b32 s47, 0
L_hg:
    s_load_dword s12, s[18:19], 0 glc
    s_add_u32 s47, s47, 1
    s_cmp_gt_u32 s47, 4000
    s_cbranch_scc1 L_hgd
    s_waitcnt lgkmcnt(0)
    s_cmp_lg_u32 s12, s56
    s_cbranch_scc1 L_hg
L_hgd:
    s_mov_b32 exec_lo, 0x11111111
    s_mov_b32 exec_hi, 0x11111111
    buffer_load_dwordx3 v[60:62], v4, s[92:95], s52 offen sc1
    s_mov_b64 exec, -1
    buffer_load_dwordx4 v[40:43], v3, s[92:95], s46 offen offset:0 sc1
    buffer_load_dwordx4 v[44:47], v3, s[92:95], s46 offen offset:1024 sc1
    s_mov_b64 exec, 1
    ds_add_u32 v12, v11 offset:36
    s_mov_b64 exec, -1
WF_30:
    ds_read_b32 v13, v12 offset:28
    s_sub_u32 s57, s57, 1
    s_cbranch_scc1 L_end
    s_waitcnt lgkmcnt(0)
    v_readfirstlane_b32 s40, v13
    s_nop 0
    s_cmp_lt_u32 s40, 1
    s_cbranch_scc1 WF_30
    ds_read_b64_tr_b16 v[104:105], v9 offset:0
    ds_read_b64_tr_b16 v[106:107], v9 offset:2080
    ds_read_b64_tr_b16 v[108:109], v9 offset:1040
    ds_read_b64_tr_b16 v[110:111], v9 offset:3120
L_h3:
    s_waitcnt vmcnt(2)
    v_mov_b32_dpp v63, v60 quad_perm:[0,0,0,0] row_mask:0xf bank_mask:0xf
    v_mov_b32_dpp v64, v61 quad_perm:[0,0,0,0] row_mask:0xf bank_mask:0xf
    v_xor_b32 v19, s56, v62
    v_max_f32_dpp v28, v63, v63 row_half_mirror row_mask:0xf bank_mask:0xf
    s_nop 1
    v_max_f32_dpp v28, v28, v28 row_ror:8 row_mask:0xf bank_mask:0xf
    v_mov_b32 v30, v28
    s_nop 1
    v_permlane16_swap_b32 v28, v30
    v_max_f32 v28, v28, v30
    v_mov_b32 v30, v28
    s_nop 1
    v_permlane32_swap_b32 v28, v30
    v_max_f32 v28, v28, v30
    v_sub_f32 v63, v63, v28
    v_exp_f32 v63, v63
    s_nop 0
    v_cvt_pk_bf16_f32 v65, v63, v63
    v_mul_f32 v29, v63, v64
    s_nop 0
    v_mov_b32_dpp v66, v65 row_half_mirror row_mask:0xf bank_mask:0xf
    v_add_f32_dpp v29, v29, v29 row_half_mirror row_mask:0xf bank_mask:0xf
    v_cndmask_b32 v30, v65, v66, s[6:7]
    v_cndmask_b32 v31, v66, v65, s[6:7]
    v_add_f32_dpp v29, v29, v29 row_ror:8 row_mask:0xf bank_mask:0xf
    v_and_b32 v32, v30, v20
    v_and_b32 v36, v31, v20
    v_and_b32 v33, v30, v21
    v_and_b32 v37, v31, v21
    v_and_b32 v34, v30, v22
    v_and_b32 v38, v31, v22
    v_and_b32 v35, v30, v23
    v_and_b32 v39, v31, v23
    s_waitcnt vmcnt(1)
    v_xor_b32 v40, v24, v40
    v_xor_b32 v41, v25, v41
    v_xor_b32 v42, v26, v42
    v_xor_b32 v43, v27, v43
    v_and_b32 v13, v40, v41
    v_bitop3_b32 v13, v42, v43, v13 bitop3:0x80
    v_mfma_f32_16x16x32_bf16 v[68:71], v[32:35], v[40:43], 0
    s_waitcnt vmcnt(0)
    v_xor_b32 v44, v24, v44
    v_xor_b32 v45, v25, v45
    v_xor_b32 v46, v26, v46
    v_xor_b32 v47, v27, v47
    v_bitop3_b32 v13, v44, v45, v13 bitop3:0x80
    v_bitop3_b32 v13, v46, v47, v13 bitop3:0x80
    v_mfma_f32_16x16x32_bf16 v[68:71], v[36:39], v[44:47], v[68:71]
    v_bitop3_b32 v13, v13, s63, s63 bitop3:0x03
    v_or_b32 v13, v13, v19
    v_cmp_ne_u32 vcc, 0, v13
    v_mov_b32 v30, v29
    s_nop 1
    v_permlane16_swap_b32 v29, v30
    v_add_f32 v29, v29, v30
    s_cbranch_vccnz L_h3r
    v_cvt_pk_bf16_f32 v56, v68, v69
    v_cvt_pk_bf16_f32 v57, v70, v71
    v_mov_b32 v30, v29
    s_nop 1
    v_permlane32_swap_b32 v29, v30
    v_add_f32 v29, v29, v30
    s_mov_b32 exec_lo, 0x00ff00ff
    s_mov_b32 exec_hi, 0xff00ff00
    ds_write_b64 v5, v[56:57]
    s_mov_b64 exec, 1
    ds_write2_b32 v16, v28, v29 offset1:8
    s_mov_b64 exec, -1
    s_waitcnt lgkmcnt(0)
    s_barrier
    ds_read_b128 v[28:31], v15
    ds_read_b128 v[40:43], v7 offset:0
    ds_read_b128 v[44:47], v7 offset:64
    s_waitcnt lgkmcnt(2)
    v_max3_f32 v13, v28, v29, v30
    v_cndmask_b32 v28, v28, v30, s[14:15]
    v_cndmask_b32 v29, v29, v31, s[14:15]
    v_max_f32 v13, v13, v31
    s_waitcnt lgkmcnt(1)
    v_mfma_f32_16x16x32_bf16 v[56:59], v[40:43], v[104:107], 0
    s_waitcnt lgkmcnt(0)
    v_mfma_f32_16x16x32_bf16 v[56:59], v[44:47], v[108:111], v[56:59]
    v_sub_f32 v28, v28, v13
    v_sub_f32 v29, v29, v13
    v_exp_f32 v28, v28
    v_exp_f32 v29, v29
    s_nop 3
    v_add_f32 v56, v56, v57
    v_add_f32 v58, v58, v59
    v_mul_f32 v56, v56, v28
    v_fmac_f32 v56, v58, v29
    v_mov_b32 v57, v56
    s_nop 1
    v_permlane16_swap_b32 v56, v57
    v_add_f32 v56, v56, v57
    v_and_or_b32 v56, v56, s41, v17
    s_mov_b32 exec_lo, 0xffff
    s_mov_b32 exec_hi, 0xffff
    buffer_store_dword v56, v8, s[92:95], s48 offen
    ds_write_b32 v10, v56
    s_mov_b64 exec, 1
    ds_add_u32 v12, v11 offset:40
    s_mov_b64 exec, -1
    s_cmp_ge_u32 s2, 72
    s_cbranch_scc1 L_end
    s_setprio 0
    s_mov_b32 s36, s24
    s_and_b32 s37, s25, 0xffff
    s_mov_b32 s38, 1152
    s_mov_b32 s39, 0x20000
    s_lshr_b32 s50, s2, 4
    s_bfe_u32 s54, s2, 0x20002
    s_and_b32 s52, s2, 3
    s_bfe_u32 s44, s2, 0x20001
    s_and_b32 s49, s2, 1
    s_cmp_ge_u32 s2, 64
    s_cselect_b32 s54, s44, s54
    s_cselect_b32 s52, s49, s52
    s_lshl_b32 s50, s50, 8
    s_lshl_b32 s52, s52, 6
    s_add_u32 s50, s50, s52
    s_and_b32 s52, s54, 1
    s_lshl_b32 s52, s52, 3
    s_add_u32 s55, s50, s52
    s_lshr_b32 s54, s54, 1
    s_mul_i32 s54, s54, 1152
    s_add_u32 s54, s54, s55
    s_lshl_b32 s44, s51, 11
    s_lshl_b32 s50, s2, 14
    s_add_u32 s50, s50, s44
    s_add_u32 s52, s50, 3407872
    s_add_u32 s50, s50, 2097152
    v_and_b32 v13, 3, v0
    v_lshlrev_b32 v90, 4, v13
    v_bfe_u32 v14, v0, 2, 2
    v_lshl_add_u32 v90, v14, 1, v90
    v_lshrrev_b32 v92, 1, v1
    v_and_b32 v14, 1, v1
    v_lshl_add_u32 v92, v14, 1, v92
    v_lshl_add_u32 v92, v92, 2, v13
    v_lshlrev_b32 v92, 5, v92
    s_lshl_b32 s44, s51, 2
    s_add_u32 s44, s44, 156864
    v_add_u32 v92, s44, v92
    v_lshlrev_b32 v93, 2, v0
    v_add_u32 v93, 156352, v93
    v_cmp_gt_u32 vcc, 4, v2
    s_nop 1
    v_cndmask_b32 v92, v93, v92, vcc
    v_lshlrev_b32 v93, 5, v2
    v_add_u32 v93, 156864, v93
WF_31:
    s_sleep 1
    ds_read_b32 v13, v12 offset:12
    s_sub_u32 s57, s57, 1
    s_cbranch_scc1 L_end
    s_waitcnt lgkmcnt(0)
    v_readfirstlane_b32 s40, v13
    s_nop 0
    s_cmp_lt_u32 s40, 1
    s_cbranch_scc1 WF_31
    buffer_load_dwordx4 v[32:35], v3, s[92:95], s52 offen sc1
    buffer_load_dwordx4 v[36:39], v3, s[92:95], s52 offen offset:1024 sc1
    s_cmp_lg_u32 s51, 0
    s_cbranch_scc1 L_nx
    buffer_load_ushort v94, v90, s[32:35], s54 offen
    buffer_load_ushort v95, v90, s[36:39], s55 offen
L_nx:
    s_mov_b32 s36, s26
    s_and_b32 s37, s27, 0xffff
    s_mov_b32 s38, 2304
    s_mov_b32 s39, 0x20000
    s_mov_b32 s47, 0
L_hs:
    s_load_dword s8, s[16:17], 0 glc
    s_load_dword s9, s[16:17], 128 glc
    s_load_dword s10, s[16:17], 256 glc
    s_load_dword s11, s[16:17], 384 glc
    s_add_u32 s47, s47, 1
    s_cmp_gt_u32 s47, 4000
    s_cbranch_scc1 L_hsd
    s_waitcnt lgkmcnt(0)
    s_xor_b32 s8, s8, s56
    s_xor_b32 s9, s9, s56
    s_xor_b32 s10, s10, s56
    s_xor_b32 s11, s11, s56
    s_or_b64 s[8:9], s[8:9], s[10:11]
    s_cbranch_scc1 L_hs
L_hsd:
    buffer_load_dwordx4 v[24:27], v3, s[92:95], s50 offen sc1
    buffer_load_dwordx4 v[28:31], v3, s[92:95], s50 offen offset:1024 sc1
    s_waitcnt vmcnt(2)
L_h4o:
    v_xor_b32 v32, s58, v32
    v_xor_b32 v33, s59, v33
    v_xor_b32 v34, s60, v34
    v_xor_b32 v35, s61, v35
    v_xor_b32 v36, s58, v36
    v_xor_b32 v37, s59, v37
    v_xor_b32 v38, s60, v38
    v_xor_b32 v39, s61, v39
    v_or3_b32 v13, v32, v33, v34
    v_or3_b32 v13, v13, v35, v36
    v_or3_b32 v13, v13, v37, v38
    v_or_b32 v13, v13, v39
    v_and_b32 v13, 0xff, v13
    v_cmp_ne_u32 vcc, 0, v13
    s_cbranch_vccnz L_h4or
    v_add_f32 v32, v32, v36
    v_add_f32 v33, v33, v37
    v_add_f32 v34, v34, v38
    v_add_f32 v35, v35, v39
    v_permlane32_swap_b32 v32, v33
    s_nop 0
    v_permlane32_swap_b32 v34, v35
    v_add_f32 v32, v32, v33
    v_add_f32 v34, v34, v35
    s_nop 1
    v_permlane16_swap_b32 v32, v34
    v_add_f32 v32, v32, v34
    s_nop 1
    v_add_f32_dpp v32, v32, v32 row_ror:4 row_mask:0xf bank_mask:0xf
    s_nop 1
    v_add_f32_dpp v32, v32, v32 row_ror:8 row_mask:0xf bank_mask:0xf
    v_lshlrev_b32 v94, 16, v94
    v_lshlrev_b32 v95, 16, v95
    s_mov_b32 exec_lo, 0x000f000f
    s_mov_b32 exec_hi, 0x000f000f
    ds_write_b32 v92, v32 offset:512
    s_mov_b64 exec, -1
    s_cmp_lg_u32 s51, 0
    s_waitcnt lgkmcnt(0)
    s_barrier
    s_cbranch_scc1 L_h4
    ds_read_b128 v[32:35], v93 offset:512
    ds_read_b128 v[36:39], v93 offset:528
    s_waitcnt lgkmcnt(0)
    v_add_f32 v32, v32, v33
    v_add_f32 v34, v34, v35
    v_add_f32 v36, v36, v37
    v_add_f32 v38, v38, v39
    v_add_f32 v32, v32, v34
    v_add_f32 v36, v36, v38
    v_add_f32 v32, v32, v36
    v_cvt_pk_bf16_f32 v32, v32, v32
    v_and_b32 v32, 0xffff0000, v32
    v_add_f32 v32, v32, v95
    v_cvt_pk_bf16_f32 v32, v32, v32
    v_and_b32 v32, 0xffff0000, v32
    v_mul_f32 v33, 0xbfb8aa3b, v32
    v_exp_f32 v33, v33
    s_nop 0
    v_add_f32 v33, 1.0, v33
    v_rcp_f32 v33, v33
    s_nop 0
    v_mul_f32 v32, v32, v33
    v_cvt_pk_bf16_f32 v32, v32, v32
    v_and_b32 v32, 0xffff0000, v32
L_h4:
    s_waitcnt vmcnt(1)
    v_xor_b32 v24, s58, v24
    v_xor_b32 v25, s59, v25
    v_xor_b32 v26, s60, v26
    v_xor_b32 v27, s61, v27
    v_or3_b32 v14, v24, v25, v26
    s_waitcnt vmcnt(0)
    v_xor_b32 v28, s58, v28
    v_xor_b32 v29, s59, v29
    v_xor_b32 v30, s60, v30
    v_xor_b32 v31, s61, v31
    v_or3_b32 v14, v14, v27, v28
    v_add_f32 v24, v24, v28
    v_add_f32 v25, v25, v29
    v_add_f32 v26, v26, v30
    v_add_f32 v27, v27, v31
    v_or3_b32 v14, v14, v29, v30
    v_or_b32 v14, v14, v31
    v_permlane32_swap_b32 v24, v25
    v_permlane32_swap_b32 v26, v27
    v_add_f32 v24, v24, v25
    v_add_f32 v26, v26, v27
    v_and_b32 v14, 0xff, v14
    v_cmp_ne_u32 vcc, 0, v14
    v_permlane16_swap_b32 v24, v26
    v_add_f32 v24, v24, v26
    s_cmp_lg_u32 s51, 0
    s_cbranch_vccnz L_h4r
    v_add_f32_dpp v24, v24, v24 row_ror:4 row_mask:0xf bank_mask:0xf
    s_nop 1
    v_add_f32_dpp v24, v24, v24 row_ror:8 row_mask:0xf bank_mask:0xf
    ds_write_b32 v92, v24
    s_waitcnt lgkmcnt(0)
    s_barrier
    s_cbranch_scc1 L_end
    ds_read_b128 v[24:27], v93
    ds_read_b128 v[28:31], v93 offset:16
    s_mov_b64 exec, 0xffff
    s_waitcnt lgkmcnt(1)
    v_add_f32 v24, v24, v25
    v_add_f32 v26, v26, v27
    s_waitcnt lgkmcnt(0)
    v_add_f32 v28, v28, v29
    v_add_f32 v30, v30, v31
    v_add_f32 v24, v24, v26
    v_add_f32 v28, v28, v30
    v_add_f32 v24, v24, v28
    v_fma_f32 v24, v24, v32, v94
    v_cvt_pk_bf16_f32 v24, v24, v24
    buffer_store_short v24, v90, s[36:39], s54 offen
    s_cmp_lg_u32 s2, 0
    s_cbranch_scc1 L_end
    v_mov_b32 v26, s56
    v_mov_b32 v27, 0
    s_mov_b64 exec, 1
    buffer_store_dword v26, v27, s[92:95], 0 offen sc1
    s_branch L_end
L_h2r:
    s_sub_u32 s57, s57, 1
    s_cbranch_scc1 L_end
    s_add_u32 s47, s47, 1
    s_cmp_lt_u32 s47, 24
    s_cbranch_scc1 L_h2g
    v_lshlrev_b32 v13, 3, v0
    buffer_load_dwordx2 v[20:21], v13, s[92:95], s49 offen sc1
    s_waitcnt vmcnt(0)
    buffer_store_dwordx2 v[20:21], v13, s[92:95], s48 offen sc1
L_h2g:
    buffer_load_dwordx4 v[24:27], v3, s[92:95], s42 offen sc1
    buffer_load_dwordx4 v[28:31], v3, s[92:95], s42 offen offset:1024 sc1
    s_branch L_h2
L_early:
    ds_read_b128 v[24:27], v5 offset:0
    ds_read_b128 v[28:31], v5 offset:16
    ds_read_b128 v[32:35], v5 offset:32
    ds_read_b128 v[36:39], v5 offset:48
    ds_read_b128 v[152:155], v5 offset:64
    ds_read_b128 v[156:159], v5 offset:80
    ds_read_b128 v[160:163], v5 offset:96
    ds_read_b128 v[164:167], v5 offset:112
    s_waitcnt lgkmcnt(7)
    v_mfma_f32_16x16x32_bf16 v[20:23], v[40:43], v[24:27], 0
    ds_read_b128 v[24:27], v5 offset:128
    s_waitcnt lgkmcnt(7)
    v_mfma_f32_16x16x32_bf16 v[20:23], v[44:47], v[28:31], v[20:23]
    ds_read_b128 v[28:31], v5 offset:144
    s_waitcnt lgkmcnt(7)
    v_mfma_f32_16x16x32_bf16 v[20:23], v[48:51], v[32:35], v[20:23]
    ds_read_b128 v[32:35], v5 offset:160
    s_waitcnt lgkmcnt(7)
    v_mfma_f32_16x16x32_bf16 v[20:23], v[52:55], v[36:39], v[20:23]
    ds_read_b128 v[36:39], v5 offset:176
    s_waitcnt lgkmcnt(7)
    v_mfma_f32_16x16x32_bf16 v[20:23], v[56:59], v[152:155], v[20:23]
    ds_read_b128 v[152:155], v5 offset:192
    s_waitcnt lgkmcnt(7)
    v_mfma_f32_16x16x32_bf16 v[20:23], v[60:63], v[156:159], v[20:23]
    ds_read_b128 v[156:159], v5 offset:208
    s_waitcnt lgkmcnt(7)
    v_mfma_f32_16x16x32_bf16 v[20:23], v[64:67], v[160:163], v[20:23]
    ds_read_b128 v[160:163], v5 offset:224
    s_waitcnt lgkmcnt(7)
    v_mfma_f32_16x16x32_bf16 v[20:23], v[68:71], v[164:167], v[20:23]
    ds_read_b128 v[164:167], v5 offset:240
    s_waitcnt lgkmcnt(7)
    v_mfma_f32_16x16x32_bf16 v[20:23], v[72:75], v[24:27], v[20:23]
    s_waitcnt lgkmcnt(6)
    v_mfma_f32_16x16x32_bf16 v[20:23], v[76:79], v[28:31], v[20:23]
    s_waitcnt lgkmcnt(5)
    v_mfma_f32_16x16x32_bf16 v[20:23], v[80:83], v[32:35], v[20:23]
    s_waitcnt lgkmcnt(4)
    v_mfma_f32_16x16x32_bf16 v[20:23], v[84:87], v[36:39], v[20:23]
    s_waitcnt lgkmcnt(3)
    v_mfma_f32_16x16x32_bf16 v[20:23], v[88:91], v[152:155], v[20:23]
    s_waitcnt lgkmcnt(2)
    v_mfma_f32_16x16x32_bf16 v[20:23], v[92:95], v[156:159], v[20:23]
    s_waitcnt lgkmcnt(1)
    v_mfma_f32_16x16x32_bf16 v[20:23], v[96:99], v[160:163], v[20:23]
    s_waitcnt lgkmcnt(0)
    v_mfma_f32_16x16x32_bf16 v[20:23], v[100:103], v[164:167], v[20:23]
    s_nop 7
    v_max3_f32 v13, v20, v21, v22
    v_max_f32 v13, v13, v23
    ds_max_f32 v4, v13
    s_waitcnt lgkmcnt(0)
    s_branch L_b3
L_n7:
    s_cmp_lt_u32 s51, 4
    s_cbranch_scc1 L_pb
WF_32:
    ds_read_b32 v13, v12 offset:0
    s_sub_u32 s57, s57, 1
    s_cbranch_scc1 L_end
    s_waitcnt lgkmcnt(0)
    v_readfirstlane_b32 s40, v13
    s_nop 0
    s_cmp_lt_u32 s40, s55
    s_cbranch_scc1 WF_32
    ds_read_b128 v[104:107], v6 offset:0
    ds_read_b128 v[108:111], v6 offset:16
    ds_read_b128 v[112:115], v6 offset:32
    ds_read_b128 v[116:119], v6 offset:48
    ds_read_b128 v[120:123], v6 offset:64
    ds_read_b128 v[124:127], v6 offset:80
    ds_read_b128 v[128:131], v6 offset:96
    ds_read_b128 v[132:135], v6 offset:112
    s_waitcnt lgkmcnt(7)
    v_mfma_f32_16x16x32_bf16 v[20:23], v[104:107], v[40:43], 0
    ds_read_b128 v[104:107], v6 offset:128
    s_waitcnt lgkmcnt(7)
    v_mfma_f32_16x16x32_bf16 v[20:23], v[108:111], v[44:47], v[20:23]
    ds_read_b128 v[108:111], v6 offset:144
    s_waitcnt lgkmcnt(7)
    v_mfma_f32_16x16x32_bf16 v[20:23], v[112:115], v[48:51], v[20:23]
    ds_read_b128 v[112:115], v6 offset:160
    s_waitcnt lgkmcnt(7)
    v_mfma_f32_16x16x32_bf16 v[20:23], v[116:119], v[52:55], v[20:23]
    ds_read_b128 v[116:119], v6 offset:176
    s_waitcnt lgkmcnt(7)
    v_mfma_f32_16x16x32_bf16 v[20:23], v[120:123], v[56:59], v[20:23]
    ds_read_b128 v[120:123], v6 offset:192
    s_waitcnt lgkmcnt(7)
    v_mfma_f32_16x16x32_bf16 v[20:23], v[124:127], v[60:63], v[20:23]
    ds_read_b128 v[124:127], v6 offset:208
    s_waitcnt lgkmcnt(7)
    v_mfma_f32_16x16x32_bf16 v[20:23], v[128:131], v[64:67], v[20:23]
    ds_read_b128 v[128:131], v6 offset:224
    s_waitcnt lgkmcnt(7)
    v_mfma_f32_16x16x32_bf16 v[20:23], v[132:135], v[68:71], v[20:23]
    ds_read_b128 v[132:135], v6 offset:240
    s_waitcnt lgkmcnt(7)
    v_mfma_f32_16x16x32_bf16 v[20:23], v[104:107], v[72:75], v[20:23]
    s_waitcnt lgkmcnt(6)
    v_mfma_f32_16x16x32_bf16 v[20:23], v[108:111], v[76:79], v[20:23]
    s_waitcnt lgkmcnt(5)
    v_mfma_f32_16x16x32_bf16 v[20:23], v[112:115], v[80:83], v[20:23]
    s_waitcnt lgkmcnt(4)
    v_mfma_f32_16x16x32_bf16 v[20:23], v[116:119], v[84:87], v[20:23]
    s_waitcnt lgkmcnt(3)
    v_mfma_f32_16x16x32_bf16 v[20:23], v[120:123], v[88:91], v[20:23]
    s_waitcnt lgkmcnt(2)
    v_mfma_f32_16x16x32_bf16 v[20:23], v[124:127], v[92:95], v[20:23]
    s_waitcnt lgkmcnt(1)
    v_mfma_f32_16x16x32_bf16 v[20:23], v[128:131], v[96:99], v[20:23]
    s_waitcnt lgkmcnt(0)
    v_mfma_f32_16x16x32_bf16 v[20:23], v[132:135], v[100:103], v[20:23]
    s_nop 7
    v_sub_f32 v40, v20, v18
    v_sub_f32 v41, v21, v18
    v_sub_f32 v42, v22, v18
    v_sub_f32 v43, v23, v18
    v_exp_f32 v40, v40
    v_exp_f32 v41, v41
    v_exp_f32 v42, v42
    v_exp_f32 v43, v43
    v_cvt_pk_bf16_f32 v40, v40, v41
    v_cvt_pk_bf16_f32 v41, v42, v43
    ds_write_b64 v15, v[40:41]
    v_max3_f32 v13, v20, v21, v22
    v_max_f32 v13, v13, v23
    ds_max_f32 v4, v13
    v_sub_f32 v13, v13, v18
    v_cmp_nle_f32 vcc, v13, s50
    s_cbranch_vccz L_pb
    v_mov_b32 v13, 1
    ds_write_b32 v12, v13 offset:48
L_pb:
    s_setprio 0
WF_33:
    ds_read_b32 v13, v12 offset:0
    s_sub_u32 s57, s57, 1
    s_cbranch_scc1 L_end
    s_waitcnt lgkmcnt(0)
    v_readfirstlane_b32 s40, v13
    s_nop 0
    s_cmp_lt_u32 s40, 157
    s_cbranch_scc1 WF_33
    ds_read_b64_tr_b16 v[136:137], v8 offset:0
    ds_read_b64_tr_b16 v[138:139], v8 offset:16640
    ds_read_b64_tr_b16 v[140:141], v8 offset:32
    ds_read_b64_tr_b16 v[142:143], v8 offset:16672
    ds_read_b64_tr_b16 v[144:145], v8 offset:64
    ds_read_b64_tr_b16 v[146:147], v8 offset:16704
    ds_read_b64_tr_b16 v[148:149], v8 offset:96
    ds_read_b64_tr_b16 v[150:151], v8 offset:16736
WF_34:
    s_sleep 1
    ds_read_b32 v13, v12 offset:0
    s_sub_u32 s57, s57, 1
    s_cbranch_scc1 L_end
    s_waitcnt lgkmcnt(0)
    v_readfirstlane_b32 s40, v13
    s_nop 0
    s_cmp_lt_u32 s40, 189
    s_cbranch_scc1 WF_34
    ds_read_b64_tr_b16 v[152:153], v8 offset:33280
    ds_read_b64_tr_b16 v[154:155], v8 offset:49920
    ds_read_b64_tr_b16 v[156:157], v8 offset:33312
    ds_read_b64_tr_b16 v[158:159], v8 offset:49952
    ds_read_b64_tr_b16 v[160:161], v8 offset:33344
    ds_read_b64_tr_b16 v[162:163], v8 offset:49984
    ds_read_b64_tr_b16 v[164:165], v8 offset:33376
    ds_read_b64_tr_b16 v[166:167], v8 offset:50016
    s_branch L_bb
L_ovf:
    v_mov_b32 v13, 1
    ds_write_b32 v12, v13 offset:48
    s_branch L_bb
L_slow:
    v_lshlrev_b32 v14, 4, v1
    v_add_u32 v14, 156224, v14
    ds_read_b128 v[44:47], v14
    ds_read_b128 v[48:51], v14 offset:1664
    ds_read_b32 v18, v4
    s_waitcnt lgkmcnt(0)
    v_ceil_f32 v18, v18
    s_cmp_lt_u32 s54, 2
    s_cbranch_scc1 L_sl2
    v_sub_f32 v40, v20, v18
    v_sub_f32 v41, v21, v18
    v_sub_f32 v42, v22, v18
    v_sub_f32 v43, v23, v18
    v_exp_f32 v40, v40
    v_exp_f32 v41, v41
    v_exp_f32 v42, v42
    v_exp_f32 v43, v43
    v_cvt_pk_bf16_f32 v40, v40, v41
    v_cvt_pk_bf16_f32 v41, v42, v43
    ds_write_b64 v15, v[40:41]
    v_mov_b32 v13, 1
    s_mov_b64 exec, 1
    ds_add_u32 v12, v13 offset:52
    s_mov_b64 exec, -1
L_sl2:
    v_ceil_f32 v44, v44
    v_sub_f32 v44, v48, v44
    v_exp_f32 v44, v44
    v_ceil_f32 v45, v45
    v_sub_f32 v45, v49, v45
    v_exp_f32 v45, v45
    v_ceil_f32 v46, v46
    v_sub_f32 v46, v50, v46
    v_exp_f32 v46, v46
    v_ceil_f32 v47, v47
    v_sub_f32 v47, v51, v47
    v_exp_f32 v47, v47
    v_mul_f32 v24, v24, v44
    v_mul_f32 v25, v25, v45
    v_mul_f32 v26, v26, v46
    v_mul_f32 v27, v27, v47
    v_mul_f32 v28, v28, v44
    v_mul_f32 v29, v29, v45
    v_mul_f32 v30, v30, v46
    v_mul_f32 v31, v31, v47
    v_mul_f32 v32, v32, v44
    v_mul_f32 v33, v33, v45
    v_mul_f32 v34, v34, v46
    v_mul_f32 v35, v35, v47
    v_mul_f32 v36, v36, v44
    v_mul_f32 v37, v37, v45
    v_mul_f32 v38, v38, v46
    v_mul_f32 v39, v39, v47
WF_35:
    ds_read_b32 v13, v12 offset:52
    s_sub_u32 s57, s57, 1
    s_cbranch_scc1 L_end
    s_waitcnt lgkmcnt(0)
    v_readfirstlane_b32 s40, v13
    s_nop 0
    s_cmp_lt_u32 s40, 4
    s_cbranch_scc1 WF_35
    v_mov_b32 v13, 0
    s_branch L_p3
L_h3r:
    s_sub_u32 s57, s57, 1
    s_cbranch_scc1 L_end
    s_mov_b32 exec_lo, 0x11111111
    s_mov_b32 exec_hi, 0x11111111
    buffer_load_dwordx3 v[60:62], v4, s[92:95], s52 offen sc1
    s_mov_b64 exec, -1
    buffer_load_dwordx4 v[40:43], v3, s[92:95], s46 offen offset:0 sc1
    buffer_load_dwordx4 v[44:47], v3, s[92:95], s46 offen offset:1024 sc1
    s_branch L_h3
L_h4or:
    s_sub_u32 s57, s57, 1
    s_cbranch_scc1 L_end
    buffer_load_dwordx4 v[32:35], v3, s[92:95], s52 offen sc1
    buffer_load_dwordx4 v[36:39], v3, s[92:95], s52 offen offset:1024 sc1
    s_waitcnt vmcnt(0)
    s_branch L_h4o
L_h4r:
    s_sub_u32 s57, s57, 1
    s_cbranch_scc1 L_end
    buffer_load_dwordx4 v[24:27], v3, s[92:95], s50 offen sc1
    buffer_load_dwordx4 v[28:31], v3, s[92:95], s50 offen offset:1024 sc1
    s_branch L_h4
L_end:
L_exit:
    s_endpgm
L_last:
.section .rodata,"a"
.p2align 6
.amdhsa_kernel recurrent_scan__compressed_kv_cla__mixer_channel_mlp__decode_kernel
  .amdhsa_next_free_vgpr 168
  .amdhsa_next_free_sgpr 102
  .amdhsa_accum_offset 168
  .amdhsa_group_segment_fixed_size 0
  .amdhsa_kernarg_size 112
  .amdhsa_user_sgpr_count 2
  .amdhsa_user_sgpr_kernarg_segment_ptr 1
  .amdhsa_system_sgpr_workgroup_id_x 1
.end_amdhsa_kernel
```
